```python
import torch

def _softmax(x, axis=-1):
    return torch.softmax(x, dim=axis)

def _gelu(x):
    return torch.nn.functional.gelu(x, approximate='tanh')

def _silu(x):
    return torch.nn.functional.silu(x)

def _sigmoid(x):
    return torch.sigmoid(x)

def _layernorm(x, axis=-1, eps=1e-05):
    m = x.mean(dim=axis, keepdim=True)
    v = x.var(dim=axis, keepdim=True, unbiased=False)
    return (x - m) / torch.sqrt(v + eps)

def _scatter_add(tgt, idx, src, axis=0):
    return tgt.clone().index_add_(axis, idx, src)

def _segment_sum(src, seg, n):
    out = torch.zeros((n,) + src.shape[1:], dtype=src.dtype)
    return out.index_add_(0, seg, src)

def _pad(x, pw):
    flat = tuple((v for pair in reversed(pw) for v in pair))
    return torch.nn.functional.pad(x, flat)
kernel_name = 'adaLN_cond__sliding_local_dilated__glu_gated_glu__prompt'

def setup_inputs():

    _w = lambda a: (lambda t: t.to(torch.bfloat16) if t.is_floating_point() else t)(torch.as_tensor(a))

    def _A_setup():
        B, S, D = (1, 2048, 512)
        return {'x': _w((lambda *s: torch.randn(*s, dtype=torch.bfloat16) * 0.05)(B, S, D)), 'wqkv': _w((lambda *s: torch.randn(*s, dtype=torch.bfloat16) * 0.05)(D, 3 * D)), 'wo': _w((lambda *s: torch.randn(*s, dtype=torch.bfloat16) * 0.05)(D, D))}
    _A_in = _A_setup()

    def _B_setup():
        B, S, D, F = (1, 2048, 512, 1792)
        return {'x': _w((lambda *s: torch.randn(*s, dtype=torch.bfloat16) * 0.05)(B, S, D)), 'w_gate': _w((lambda *s: torch.randn(*s, dtype=torch.bfloat16) * 0.05)(D, F)), 'w_up': _w((lambda *s: torch.randn(*s, dtype=torch.bfloat16) * 0.05)(D, F)), 'w_down': _w((lambda *s: torch.randn(*s, dtype=torch.bfloat16) * 0.05)(F, D))}
    _B_in = _B_setup()
    return {'A_x': _A_in['x'], 'A_wqkv': _A_in['wqkv'], 'A_wo': _A_in['wo'], 'B_x': _B_in['x'], 'B_w_gate': _B_in['w_gate'], 'B_w_up': _B_in['w_up'], 'B_w_down': _B_in['w_down'], 'c': _w((lambda *s: torch.randn(*s, dtype=torch.bfloat16) * 0.1)(1, 512) * 8.0), 'w_mod': _w((lambda *s: torch.randn(*s, dtype=torch.bfloat16) * 0.1)(512, 6 * 512) * 512 ** (-0.5) * 8.0)}

def reference(A_x, A_wqkv, A_wo, B_x, B_w_gate, B_w_up, B_w_down, c, w_mod):

    def _A_ref(x, wqkv, wo):
        B, S, D = x.shape
        H = 32
        Dh = D // H
        W, dil = (8, 2)
        qkv = (lambda x, *d: x.permute(*d))((x @ wqkv).reshape(B, S, 3, H, Dh), 2, 0, 3, 1, 4)
        q, k, v = (qkv[0], qkv[1], qkv[2])
        scale = Dh ** (-0.5)
        pos = torch.arange(S)
        off = torch.arange(W) * dil
        idx = pos[:, None] - off[None, :]
        mask = idx >= 0
        idx_c = torch.where(mask, idx, 0).reshape(-1)
        kg = k[:, :, idx_c, :].reshape(B, H, S, W, Dh)
        vg = v[:, :, idx_c, :].reshape(B, H, S, W, Dh)
        logits = torch.einsum('bhsd,bhswd->bhsw', q, kg) * scale
        logits = torch.where(mask[None, None, :, :], logits, -1000000000.0)
        attn = _softmax(logits, axis=-1)
        o = torch.einsum('bhsw,bhswd->bhsd', attn, vg)
        return (lambda x, *d: x.permute(*d))(o, 0, 2, 1, 3).reshape(B, S, D) @ wo

    def _B_ref(x, w_gate, w_up, w_down):
        g = torch.einsum('bsd,df->bsf', x, w_gate)
        u = torch.einsum('bsd,df->bsf', x, w_up)
        h = _sigmoid(g) * u
        return torch.einsum('bsf,fd->bsd', h, w_down)
    x = A_x
    mod = (_silu(c) @ w_mod).reshape(c.shape[0], 6, 1, -1)
    sa, ca, ga, sb, cb, gb = (mod[:, 0].clone(), mod[:, 1].clone(), mod[:, 2].clone(), mod[:, 3].clone(), mod[:, 4].clone(), mod[:, 5].clone())
    h = _layernorm(x, axis=-1) * (1 + ca) + sa
    x = x + ga * _A_ref(h, A_wqkv, A_wo)
    h = _layernorm(x, axis=-1) * (1 + cb) + sb
    x = x + gb * _B_ref(h, B_w_gate, B_w_up, B_w_down)
    return x
```

```asm
; @launch grid=(256,1,1) block=(256,1,1) lds=163840
.amdgcn_target "amdgcn-amd-amdhsa--gfx950"

.text
.globl adaLN_cond__sliding_local_dilated__glu_gated_glu__prompt_kernel
.p2align 8
.type adaLN_cond__sliding_local_dilated__glu_gated_glu__prompt_kernel,@function
adaLN_cond__sliding_local_dilated__glu_gated_glu__prompt_kernel:
    s_cmp_ge_u32 s2, 256
    s_cbranch_scc1 L_end_adaLN_cond__sliding_local_dilated__glu_gated_glu__prompt_kernel
    s_load_dwordx16 s[36:51], s[0:1], 0
    s_load_dwordx8 s[52:59], s[0:1], 64
    s_getpc_b64 s[24:25]
L_pc:
    v_lshrrev_b32 v1, 6, v0
    s_nop 0
    v_readfirstlane_b32 s3, v1
    v_and_b32 v0, 63, v0
    v_lshlrev_b32 v1, 4, v0
    s_and_b32 s30, s2, 7
    s_lshr_b32 s31, s2, 3
    s_and_b32 s4, s31, 3
    s_lshl_b32 s26, s30, 2
    s_add_u32 s4, s4, s26
    s_lshr_b32 s5, s31, 2
    s_lshr_b32 s6, s4, 1
    s_lshl_b32 s6, s6, 2
    s_add_u32 s6, s6, s3
    s_lshl_b32 s33, s5, 1
    s_and_b32 s26, s31, 1
    s_add_u32 s33, s33, s26
    s_mov_b32 s7, 0xffff0000
    s_lshl_b32 s26, s31, 2
    s_add_u32 s26, s26, s3
    s_mov_b32 s27, (L_code_end - L_pc) >> 10
    s_cmp_ge_u32 s26, s27
    s_cselect_b32 s26, 0, s26
    s_lshl_b32 s26, s26, 10
    v_add_u32 v2, s26, v1
    global_load_dwordx4 v[244:247], v2, s[24:25]
    s_waitcnt lgkmcnt(0)
    s_load_dword s96, s[58:59], 32768
    s_mov_b32 s12, s58
    s_mov_b32 s13, s59
    s_mov_b32 s14, 0xd00000
    s_mov_b32 s15, 0x20000
    s_mov_b32 s8, s36
    s_mov_b32 s9, s37
    s_mov_b32 s10, 0x200000
    s_mov_b32 s11, 0x20000
    s_mov_b32 s16, s38
    s_mov_b32 s17, s39
    s_mov_b32 s18, 0x180000
    s_mov_b32 s19, 0x20000
    s_mov_b32 s20, s52
    s_mov_b32 s21, s53
    s_mov_b32 s22, 0x300000
    s_mov_b32 s23, 0x20000
    s_lshl_b32 s26, s3, 8
    v_lshlrev_b32 v4, 2, v0
    v_add_u32 v5, s26, v4
    global_load_dword v6, v5, s[50:51]
    v_lshrrev_b32 v7, 2, v0
    v_mul_u32_u24 v7, 6144, v7
    v_and_b32 v5, 3, v0
    v_lshl_add_u32 v7, v5, 4, v7
    s_mul_i32 s26, s3, 786432
    s_lshr_b32 s24, s2, 3
    s_lshr_b32 s25, s24, 1
    s_lshl_b32 s100, s25, 4
    s_and_b32 s25, s2, 7
    s_lshl_b32 s25, s25, 1
    s_add_u32 s100, s100, s25
    s_and_b32 s25, s24, 1
    s_add_u32 s100, s100, s25
    s_lshl_b32 s27, s100, 6
    s_add_u32 s26, s26, s27
    s_cmp_lt_u32 s2, 96
    s_cselect_b32 s26, s26, 0x40000000
    s_lshl_b32 s27, s3, 13
    s_add_u32 m0, s27, 8192
    s_nop 0
    buffer_load_dwordx4 v7, s[20:23], s26 offen lds
    s_add_u32 m0, s27, 9216
    s_add_u32 s26, s26, 98304
    buffer_load_dwordx4 v7, s[20:23], s26 offen lds
    s_add_u32 m0, s27, 10240
    s_add_u32 s26, s26, 98304
    buffer_load_dwordx4 v7, s[20:23], s26 offen lds
    s_add_u32 m0, s27, 11264
    s_add_u32 s26, s26, 98304
    buffer_load_dwordx4 v7, s[20:23], s26 offen lds
    s_add_u32 m0, s27, 12288
    s_add_u32 s26, s26, 98304
    buffer_load_dwordx4 v7, s[20:23], s26 offen lds
    s_add_u32 m0, s27, 13312
    s_add_u32 s26, s26, 98304
    buffer_load_dwordx4 v7, s[20:23], s26 offen lds
    s_add_u32 m0, s27, 14336
    s_add_u32 s26, s26, 98304
    buffer_load_dwordx4 v7, s[20:23], s26 offen lds
    s_add_u32 m0, s27, 15360
    s_add_u32 s26, s26, 98304
    buffer_load_dwordx4 v7, s[20:23], s26 offen lds
    s_lshl_b32 s26, s4, 6
    s_lshr_b32 s27, s3, 1
    s_and_b32 s28, s3, 1
    s_lshl_b32 s31, s28, 3
    s_add_u32 s31, s31, s27
    s_add_u32 s31, s31, s26
    s_sub_u32 s31, s31, 16
    s_lshl_b32 s27, s3, 3
    s_add_u32 s29, s26, s27
    s_lshl_b32 s29, s29, 10
    s_max_i32 s30, s31, 0
    s_lshl_b32 s30, s30, 10
    buffer_load_dwordx4 v[20:23], v1, s[8:11], s30 offen
    s_add_u32 s31, s31, 2
    s_max_i32 s30, s31, 0
    s_lshl_b32 s30, s30, 10
    buffer_load_dwordx4 v[28:31], v1, s[8:11], s30 offen
    s_add_u32 s31, s31, 2
    s_max_i32 s30, s31, 0
    s_lshl_b32 s30, s30, 10
    buffer_load_dwordx4 v[36:39], v1, s[8:11], s30 offen
    s_add_u32 s31, s31, 2
    s_max_i32 s30, s31, 0
    s_lshl_b32 s30, s30, 10
    buffer_load_dwordx4 v[44:47], v1, s[8:11], s30 offen
    v_lshrrev_b32 v12, 3, v0
    v_and_b32 v13, 7, v0
    v_bfe_u32 v14, v0, 4, 1
    v_lshlrev_b32 v14, 1, v14
    v_xor_b32 v13, v13, v14
    v_mul_u32_u24 v12, 3072, v12
    v_lshl_add_u32 v8, v13, 4, v12
    v_xor_b32 v13, 4, v13
    v_lshl_add_u32 v9, v13, 4, v12
    s_mul_i32 s34, s3, 49152
    s_lshl_b32 s35, s5, 7
    s_add_u32 s34, s34, s35
    s_mul_i32 s35, s3, 6144
    s_and_b32 s91, s4, 3
    s_lshl_b32 s91, s91, 1
    v_lshrrev_b32 v12, 4, v0
    v_bfe_u32 v13, v0, 2, 2
    v_and_b32 v14, 3, v0
    v_mul_u32_u24 v15, 3072, v12
    v_lshl_add_u32 v15, v13, 7, v15
    v_lshrrev_b32 v10, 1, v14
    s_lshl_b32 s28, s3, 1
    v_add_u32 v10, s28, v10
    v_bfe_u32 v13, v13, 1, 1
    v_and_b32 v12, 1, v12
    v_lshl_or_b32 v13, v12, 1, v13
    v_lshlrev_b32 v13, 1, v13
    v_xor_b32 v10, v10, v13
    v_lshl_add_u32 v15, v10, 4, v15
    v_and_b32 v14, 1, v14
    v_lshl_add_u32 v15, v14, 3, v15
    v_mov_b32 v10, v15
    s_add_u32 s30, s29, 0
    buffer_load_dwordx4 v[52:55], v1, s[8:11], s30 offen offset:0
    v_lshrrev_b32 v12, 3, v0
    v_and_b32 v13, 7, v0
    v_bfe_u32 v14, v0, 4, 1
    v_lshlrev_b32 v14, 2, v14
    v_xor_b32 v13, v13, v14
    v_lshlrev_b32 v12, 10, v12
    v_lshl_add_u32 v241, v13, 4, v12
    v_lshrrev_b32 v12, 5, v0
    buffer_load_dwordx4 v[60:63], v1, s[8:11], s30 offen offset:2048
    v_bfe_u32 v13, v0, 4, 1
    v_bfe_u32 v14, v0, 2, 2
    v_lshl_add_u32 v12, v12, 2, v14
    v_lshlrev_b32 v12, 7, v12
    v_bfe_u32 v15, v0, 1, 1
    v_lshl_or_b32 v15, v13, 1, v15
    v_bfe_u32 v14, v14, 1, 1
    v_lshl_or_b32 v15, v14, 2, v15
    s_add_u32 s30, s29, 4096
    buffer_load_dwordx4 v[68:71], v1, s[8:11], s30 offen offset:0
    v_lshl_add_u32 v12, v15, 4, v12
    v_and_b32 v13, 1, v0
    v_lshl_add_u32 v242, v13, 3, v12
    s_and_b32 s24, s3, 1
    s_lshl_b32 s24, s24, 6
    v_xor_b32 v242, s24, v242
    v_xor_b32 v243, 64, v242
    s_bitcmp1_b32 s3, 0
    s_cselect_b32 s20, s46, s44
    s_cselect_b32 s21, s47, s45
    buffer_load_dwordx4 v[76:79], v1, s[8:11], s30 offen offset:2048
    s_mov_b32 s22, 1835008
    s_mov_b32 s23, 0x20000
    s_and_b32 s72, s3, 1
    s_lshl_b32 s72, s72, 2
    v_add_u32 v12, 0, v0
    v_mul_u32_u24 v13, 4682, v12
    v_lshrrev_b32 v13, 16, v13
    v_mul_u32_u24 v14, 14, v13
    s_add_u32 s30, s29, 0
    buffer_load_dwordx4 v[84:87], v1, s[8:11], s30 offen offset:1024
    v_sub_u32 v14, v12, v14
    v_xor_b32 v13, s72, v13
    v_mul_u32_u24 v13, 3584, v13
    v_lshl_add_u32 v232, v14, 4, v13
    v_add_u32 v12, 64, v0
    v_mul_u32_u24 v13, 4682, v12
    v_lshrrev_b32 v13, 16, v13
    v_mul_u32_u24 v14, 14, v13
    buffer_load_dwordx4 v[92:95], v1, s[8:11], s30 offen offset:3072
    v_sub_u32 v14, v12, v14
    v_xor_b32 v13, s72, v13
    v_mul_u32_u24 v13, 3584, v13
    v_lshl_add_u32 v233, v14, 4, v13
    v_add_u32 v12, 128, v0
    v_mul_u32_u24 v13, 4682, v12
    v_lshrrev_b32 v13, 16, v13
    s_add_u32 s30, s29, 4096
    buffer_load_dwordx4 v[100:103], v1, s[8:11], s30 offen offset:1024
    v_mul_u32_u24 v14, 14, v13
    v_sub_u32 v14, v12, v14
    v_xor_b32 v13, s72, v13
    v_mul_u32_u24 v13, 3584, v13
    v_lshl_add_u32 v234, v14, 4, v13
    v_add_u32 v12, 192, v0
    v_mul_u32_u24 v13, 4682, v12
    v_lshrrev_b32 v13, 16, v13
    buffer_load_dwordx4 v[108:111], v1, s[8:11], s30 offen offset:3072
    v_mul_u32_u24 v14, 14, v13
    v_sub_u32 v14, v12, v14
    v_xor_b32 v13, s72, v13
    v_mul_u32_u24 v13, 3584, v13
    v_lshl_add_u32 v235, v14, 4, v13
    v_add_u32 v12, 256, v0
    v_mul_u32_u24 v13, 4682, v12
    v_lshrrev_b32 v13, 16, v13
    s_add_u32 s30, s29, 32768
    buffer_load_dwordx4 v[116:119], v1, s[8:11], s30 offen offset:0
    v_mul_u32_u24 v14, 14, v13
    v_sub_u32 v14, v12, v14
    v_xor_b32 v13, s72, v13
    v_mul_u32_u24 v13, 3584, v13
    v_lshl_add_u32 v236, v14, 4, v13
    v_add_u32 v12, 320, v0
    v_mul_u32_u24 v13, 4682, v12
    v_lshrrev_b32 v13, 16, v13
    buffer_load_dwordx4 v[124:127], v1, s[8:11], s30 offen offset:2048
    v_mul_u32_u24 v14, 14, v13
    v_sub_u32 v14, v12, v14
    v_xor_b32 v13, s72, v13
    v_mul_u32_u24 v13, 3584, v13
    v_lshl_add_u32 v237, v14, 4, v13
    v_add_u32 v12, 384, v0
    v_mul_u32_u24 v13, 4682, v12
    v_lshrrev_b32 v13, 16, v13
    s_add_u32 s30, s29, 36864
    buffer_load_dwordx4 v[132:135], v1, s[8:11], s30 offen offset:0
    v_mul_u32_u24 v14, 14, v13
    v_sub_u32 v14, v12, v14
    v_xor_b32 v13, s72, v13
    v_mul_u32_u24 v13, 3584, v13
    v_lshl_add_u32 v238, v14, 4, v13
    s_lshr_b32 s24, s3, 1
    s_mul_i32 s60, s24, 114688
    buffer_load_dwordx4 v[140:143], v1, s[8:11], s30 offen offset:2048
    s_mul_i32 s25, s33, 224
    s_add_u32 s60, s60, s25
    s_mul_i32 s61, s24, 14336
    s_and_b32 s24, s3, 1
    s_mul_i32 s24, s24, 7168
    s_add_u32 s61, s61, s24
    v_lshrrev_b32 v12, 5, v0
    v_bfe_u32 v13, v0, 4, 1
    s_add_u32 s30, s29, 32768
    buffer_load_dwordx4 v[148:151], v1, s[8:11], s30 offen offset:1024
    v_bfe_u32 v14, v0, 2, 2
    v_and_b32 v15, 3, v0
    v_xor_b32 v12, v12, v13
    v_lshl_add_u32 v12, v12, 2, v14
    v_mul_u32_u24 v12, 224, v12
    v_mul_u32_u24 v13, 7168, v13
    v_add_u32 v12, v12, v13
    v_lshl_add_u32 v12, v15, 3, v12
    buffer_load_dwordx4 v[156:159], v1, s[8:11], s30 offen offset:3072
    v_add_u32 v239, 106496, v12
    v_add_u32 v240, 0, v12
    s_lshr_b32 s92, s3, 1
    s_lshl_b32 s24, s4, 1
    s_add_u32 s92, s92, s24
    s_and_b32 s93, s3, 1
    s_lshl_b32 s24, s4, 6
    s_lshl_b32 s25, s5, 2
    s_add_u32 s30, s29, 36864
    buffer_load_dwordx4 v[164:167], v1, s[8:11], s30 offen offset:1024
    s_add_u32 s24, s24, s25
    s_add_u32 s24, s24, s3
    s_lshl_b32 s24, s24, 10
    s_add_u32 s73, s24, 1048576
    s_add_u32 s74, s73, 32768
    s_lshl_b32 s24, s92, 15
    s_lshl_b32 s25, s5, 7
    s_add_u32 s24, s24, s25
    buffer_load_dwordx4 v[172:175], v1, s[8:11], s30 offen offset:3072
    s_lshl_b32 s25, s93, 6
    s_add_u32 s86, s24, s25
    s_lshl_b32 s87, s4, 7
    s_lshl_b32 s24, s5, 2
    s_add_u32 s24, s24, s3
    s_lshl_b32 s24, s24, 2
    s_add_u32 s94, s87, s24
    s_mov_b32 s16, s38
    s_mov_b32 s17, s39
    s_mov_b32 s18, 1572864
    s_mov_b32 s19, 0x20000
    s_mul_i32 s24, s2, 6144
    s_sub_u32 s25, s3, 1
    s_mul_i32 s26, s25, 6144
    s_add_u32 s24, s24, s26
    s_cmp_lt_u32 s25, 1
    s_cselect_b32 s24, s24, 0x40000000
    v_min_u32 v2, 47, v0
    v_lshlrev_b32 v2, 7, v2
    buffer_load_dword v252, v2, s[16:19], s24 offen
    s_mov_b32 s16, s40
    s_mov_b32 s17, s41
    s_mov_b32 s18, 524288
    s_mov_b32 s19, 0x20000
    s_mul_i32 s24, s2, 2048
    s_sub_u32 s25, s3, 0
    s_mul_i32 s26, s25, 2048
    s_add_u32 s24, s24, s26
    s_cmp_lt_u32 s25, 1
    s_cselect_b32 s24, s24, 0x40000000
    v_min_u32 v2, 15, v0
    v_lshlrev_b32 v2, 7, v2
    buffer_load_dword v252, v2, s[16:19], s24 offen
    s_mov_b32 s16, s38
    s_mov_b32 s17, s39
    s_mov_b32 s18, 0x180000
    s_mov_b32 s19, 0x20000
    s_waitcnt lgkmcnt(0)
    s_add_u32 s96, s96, 1
    s_add_u32 s28, s34, 0
    s_add_u32 m0, s35, 81920
    s_nop 0
    buffer_load_dwordx4 v8, s[16:19], s28 offen offset:0 lds
    s_waitcnt vmcnt(31)
    v_lshlrev_b32 v12, 16, v6
    v_and_b32 v13, s7, v6
    v_mul_f32 v14, 0xbfb8aa3b, v12
    v_mul_f32 v15, 0xbfb8aa3b, v13
    v_exp_f32 v14, v14
    v_exp_f32 v15, v15
    v_add_f32 v14, 1.0, v14
    v_add_f32 v15, 1.0, v15
    v_rcp_f32 v14, v14
    v_rcp_f32 v15, v15
    v_mul_f32 v14, v14, v12
    v_mul_f32 v15, v15, v13
    v_cvt_pk_bf16_f32 v14, v14, v15
    buffer_load_dwordx4 v8, s[16:19], s28 offen offset:1024 lds
    s_lshl_b32 s32, s3, 8
    v_add_u32 v12, s32, v4
    ds_write_b32 v12, v14 offset:0
    v_lshrrev_b32 v13, 5, v0
    v_lshlrev_b32 v12, 3, v13
    v_add_u32 v12, s32, v12
    v_bfe_u32 v14, v0, 2, 2
    v_lshl_add_u32 v13, v13, 2, v14
    v_lshlrev_b32 v13, 6, v13
    v_bfe_u32 v14, v0, 4, 1
    v_lshl_add_u32 v13, v14, 5, v13
    v_and_b32 v14, 3, v0
    buffer_load_dwordx4 v8, s[16:19], s28 offen offset:2048 lds
    v_lshl_add_u32 v13, v14, 3, v13
    s_lshl_b32 s32, s3, 13
    v_add_u32 v13, s32, v13
    s_waitcnt vmcnt(25)
    s_waitcnt lgkmcnt(0)
    ds_read_b64 v[176:177], v12 offset:0
    ds_read_b64_tr_b16 v[184:185], v13 offset:8192
    ds_read_b64 v[178:179], v12 offset:16
    ds_read_b64_tr_b16 v[186:187], v13 offset:8704
    s_waitcnt lgkmcnt(0)
    v_mfma_f32_32x32x16_bf16 v[192:207], v[176:179], v[184:187], 0
    ds_read_b64 v[180:181], v12 offset:32
    ds_read_b64_tr_b16 v[188:189], v13 offset:9216
    ds_read_b64 v[182:183], v12 offset:48
    s_add_u32 s28, s34, 24576
    s_add_u32 m0, s35, 84992
    s_nop 0
    buffer_load_dwordx4 v9, s[16:19], s28 offen offset:0 lds
    ds_read_b64_tr_b16 v[190:191], v13 offset:9728
    s_waitcnt lgkmcnt(0)
    v_mfma_f32_32x32x16_bf16 v[192:207], v[180:183], v[188:191], v[192:207]
    ds_read_b64 v[176:177], v12 offset:64
    ds_read_b64_tr_b16 v[184:185], v13 offset:10240
    ds_read_b64 v[178:179], v12 offset:80
    ds_read_b64_tr_b16 v[186:187], v13 offset:10752
    s_waitcnt lgkmcnt(0)
    v_mfma_f32_32x32x16_bf16 v[192:207], v[176:179], v[184:187], v[192:207]
    ds_read_b64 v[180:181], v12 offset:96
    ds_read_b64_tr_b16 v[188:189], v13 offset:11264
    ds_read_b64 v[182:183], v12 offset:112
    ds_read_b64_tr_b16 v[190:191], v13 offset:11776
    s_waitcnt lgkmcnt(0)
    v_mfma_f32_32x32x16_bf16 v[192:207], v[180:183], v[188:191], v[192:207]
    buffer_load_dwordx4 v9, s[16:19], s28 offen offset:1024 lds
    ds_read_b64 v[176:177], v12 offset:128
    ds_read_b64_tr_b16 v[184:185], v13 offset:12288
    ds_read_b64 v[178:179], v12 offset:144
    ds_read_b64_tr_b16 v[186:187], v13 offset:12800
    s_waitcnt lgkmcnt(0)
    v_mfma_f32_32x32x16_bf16 v[192:207], v[176:179], v[184:187], v[192:207]
    ds_read_b64 v[180:181], v12 offset:160
    ds_read_b64_tr_b16 v[188:189], v13 offset:13312
    ds_read_b64 v[182:183], v12 offset:176
    ds_read_b64_tr_b16 v[190:191], v13 offset:13824
    s_waitcnt lgkmcnt(0)
    v_mfma_f32_32x32x16_bf16 v[192:207], v[180:183], v[188:191], v[192:207]
    ds_read_b64 v[176:177], v12 offset:192
    ds_read_b64_tr_b16 v[184:185], v13 offset:14336
    ds_read_b64 v[178:179], v12 offset:208
    buffer_load_dwordx4 v9, s[16:19], s28 offen offset:2048 lds
    ds_read_b64_tr_b16 v[186:187], v13 offset:14848
    s_waitcnt lgkmcnt(0)
    v_mfma_f32_32x32x16_bf16 v[192:207], v[176:179], v[184:187], v[192:207]
    ds_read_b64 v[180:181], v12 offset:224
    ds_read_b64_tr_b16 v[188:189], v13 offset:15360
    ds_read_b64 v[182:183], v12 offset:240
    ds_read_b64_tr_b16 v[190:191], v13 offset:15872
    s_waitcnt lgkmcnt(0)
    v_mfma_f32_32x32x16_bf16 v[192:207], v[180:183], v[188:191], v[192:207]
    v_and_b32 v5, 31, v0
    v_lshlrev_b32 v12, 2, v5
    s_lshl_b32 s32, s3, 7
    v_add_u32 v12, s32, v12
    s_nop 7
    ds_write_b32 v12, v192 offset:1024
    s_cmp_lg_u32 s3, 3
    s_cbranch_scc1 L_noreg_1
    s_getreg_b32 s24, hwreg(HW_REG_XCC_ID, 0, 4)
    s_lshl_b32 s25, s96, 4
    s_or_b32 s25, s25, s24
    s_and_b32 s24, s2, 7
    s_lshl_b32 s24, s24, 9
    s_lshr_b32 s26, s2, 3
    s_lshr_b32 s27, s26, 3
    s_lshl_b32 s27, s27, 7
    s_add_u32 s24, s24, s27
    s_and_b32 s26, s26, 7
    s_lshl_b32 s26, s26, 2
    s_add_u32 s24, s24, s26
    s_add_u32 s24, s24, 36864
    v_mov_b32 v2, 0
    v_mov_b32 v3, s25
    s_mov_b64 exec, 1
    buffer_store_dword v3, v2, s[12:15], s24 offen sc1
    s_mov_b64 exec, -1
L_noreg_1:
    s_cmp_lg_u32 s3, 1
    s_cbranch_scc1 L_nowarm_2
    v_and_b32 v2, 1, v0
    v_lshlrev_b32 v2, 7, v2
    s_lshl_b32 s24, s4, 7
    buffer_load_dword v252, v2, s[12:15], s24 offen sc1
    s_lshr_b32 s24, s4, 1
    s_lshl_b32 s24, s24, 8
    s_add_u32 s24, s24, 4096
    buffer_load_dword v252, v2, s[12:15], s24 offen sc1
    s_lshr_b32 s24, s4, 1
    s_lshl_b32 s24, s24, 8
    s_add_u32 s24, s24, 8192
    buffer_load_dword v252, v2, s[12:15], s24 offen sc1
L_nowarm_2:
    s_waitcnt lgkmcnt(0)
    s_barrier
    s_cmp_lg_u32 s3, 0
    s_cbranch_scc1 L_nomod_3
    s_cmp_ge_u32 s2, 96
    s_cbranch_scc1 L_nomod_3
    v_lshlrev_b32 v6, 2, v5
    ds_read_b32 v176, v6 offset:1024
    ds_read_b32 v177, v6 offset:1152
    ds_read_b32 v178, v6 offset:1280
    ds_read_b32 v179, v6 offset:1408
    s_waitcnt lgkmcnt(2)
    v_add_f32 v176, v176, v177
    s_waitcnt lgkmcnt(0)
    v_add_f32 v178, v178, v179
    v_add_f32 v176, v176, v178
    v_cvt_pk_bf16_f32 v176, v176, v176
    v_lshlrev_b32 v176, 16, v176
    v_add_f32 v177, 1.0, v176
    v_cvt_pk_bf16_f32 v177, v177, v177
    v_lshlrev_b32 v177, 16, v177
    s_lshr_b32 s26, s100, 4
    s_cmp_eq_u32 s26, 1
    s_cselect_b32 s27, 1, 0
    s_cmp_eq_u32 s26, 4
    s_cselect_b32 s27, 1, s27
    s_cmp_eq_u32 s27, 1
    s_cselect_b64 vcc, -1, 0
    v_cndmask_b32 v176, v176, v177, vcc
    v_mov_b32 v177, s96
    v_lshlrev_b32 v5, 3, v5
    s_lshl_b32 s26, s100, 8
    s_add_u32 s26, s26, 262144
    buffer_store_dwordx2 v[176:177], v5, s[12:15], s26 offen sc1
L_nomod_3:
    s_add_u32 s28, s34, 196608
    s_add_u32 m0, s35, 106496
    s_nop 0
    buffer_load_dwordx4 v8, s[16:19], s28 offen offset:0 lds
    v_mov_b32 v253, 0x3f803f80
    s_waitcnt vmcnt(28)
    v_dot2_f32_bf16 v192, v20, v253, 0
    v_dot2_f32_bf16 v212, v20, v20, 0
    s_waitcnt vmcnt(27)
    v_dot2_f32_bf16 v193, v28, v253, 0
    v_dot2_f32_bf16 v213, v28, v28, 0
    v_dot2c_f32_bf16 v192, v21, v253
    v_dot2c_f32_bf16 v212, v21, v21
    v_dot2c_f32_bf16 v193, v29, v253
    v_dot2c_f32_bf16 v213, v29, v29
    v_dot2c_f32_bf16 v192, v22, v253
    v_dot2c_f32_bf16 v212, v22, v22
    v_dot2c_f32_bf16 v193, v30, v253
    v_dot2c_f32_bf16 v213, v30, v30
    v_dot2c_f32_bf16 v192, v23, v253
    v_dot2c_f32_bf16 v212, v23, v23
    v_dot2c_f32_bf16 v193, v31, v253
    v_dot2c_f32_bf16 v213, v31, v31
    s_waitcnt vmcnt(26)
    v_dot2_f32_bf16 v194, v36, v253, 0
    v_dot2_f32_bf16 v214, v36, v36, 0
    buffer_load_dwordx4 v8, s[16:19], s28 offen offset:1024 lds
    s_waitcnt vmcnt(26)
    v_dot2_f32_bf16 v195, v44, v253, 0
    v_dot2_f32_bf16 v215, v44, v44, 0
    v_dot2c_f32_bf16 v194, v37, v253
    v_dot2c_f32_bf16 v214, v37, v37
    v_dot2c_f32_bf16 v195, v45, v253
    v_dot2c_f32_bf16 v215, v45, v45
    v_dot2c_f32_bf16 v194, v38, v253
    v_dot2c_f32_bf16 v214, v38, v38
    v_dot2c_f32_bf16 v195, v46, v253
    v_dot2c_f32_bf16 v215, v46, v46
    v_dot2c_f32_bf16 v194, v39, v253
    v_dot2c_f32_bf16 v214, v39, v39
    v_dot2c_f32_bf16 v195, v47, v253
    v_dot2c_f32_bf16 v215, v47, v47
    s_waitcnt vmcnt(25)
    v_dot2_f32_bf16 v196, v52, v253, 0
    v_dot2_f32_bf16 v216, v52, v52, 0
    s_waitcnt vmcnt(24)
    v_dot2_f32_bf16 v197, v60, v253, 0
    v_dot2_f32_bf16 v217, v60, v60, 0
    buffer_load_dwordx4 v8, s[16:19], s28 offen offset:2048 lds
    v_dot2c_f32_bf16 v196, v53, v253
    v_dot2c_f32_bf16 v216, v53, v53
    v_dot2c_f32_bf16 v197, v61, v253
    v_dot2c_f32_bf16 v217, v61, v61
    v_dot2c_f32_bf16 v196, v54, v253
    v_dot2c_f32_bf16 v216, v54, v54
    v_dot2c_f32_bf16 v197, v62, v253
    v_dot2c_f32_bf16 v217, v62, v62
    v_dot2c_f32_bf16 v196, v55, v253
    v_dot2c_f32_bf16 v216, v55, v55
    v_dot2c_f32_bf16 v197, v63, v253
    v_dot2c_f32_bf16 v217, v63, v63
    s_waitcnt vmcnt(24)
    v_dot2_f32_bf16 v198, v68, v253, 0
    v_dot2_f32_bf16 v218, v68, v68, 0
    s_waitcnt vmcnt(23)
    v_dot2_f32_bf16 v199, v76, v253, 0
    v_dot2_f32_bf16 v219, v76, v76, 0
    v_dot2c_f32_bf16 v198, v69, v253
    v_dot2c_f32_bf16 v218, v69, v69
    s_add_u32 s28, s34, 221184
    s_add_u32 m0, s35, 109568
    s_nop 0
    buffer_load_dwordx4 v9, s[16:19], s28 offen offset:0 lds
    v_dot2c_f32_bf16 v199, v77, v253
    v_dot2c_f32_bf16 v219, v77, v77
    v_dot2c_f32_bf16 v198, v70, v253
    v_dot2c_f32_bf16 v218, v70, v70
    v_dot2c_f32_bf16 v199, v78, v253
    v_dot2c_f32_bf16 v219, v78, v78
    v_dot2c_f32_bf16 v198, v71, v253
    v_dot2c_f32_bf16 v218, v71, v71
    v_dot2c_f32_bf16 v199, v79, v253
    v_dot2c_f32_bf16 v219, v79, v79
    s_waitcnt vmcnt(23)
    v_dot2_f32_bf16 v200, v84, v253, 0
    v_dot2_f32_bf16 v220, v84, v84, 0
    s_waitcnt vmcnt(22)
    v_dot2_f32_bf16 v201, v92, v253, 0
    v_dot2_f32_bf16 v221, v92, v92, 0
    v_dot2c_f32_bf16 v200, v85, v253
    v_dot2c_f32_bf16 v220, v85, v85
    v_dot2c_f32_bf16 v201, v93, v253
    v_dot2c_f32_bf16 v221, v93, v93
    v_dot2c_f32_bf16 v200, v86, v253
    buffer_load_dwordx4 v9, s[16:19], s28 offen offset:1024 lds
    v_dot2c_f32_bf16 v220, v86, v86
    v_dot2c_f32_bf16 v201, v94, v253
    v_dot2c_f32_bf16 v221, v94, v94
    v_dot2c_f32_bf16 v200, v87, v253
    v_dot2c_f32_bf16 v220, v87, v87
    v_dot2c_f32_bf16 v201, v95, v253
    v_dot2c_f32_bf16 v221, v95, v95
    s_waitcnt vmcnt(22)
    v_dot2_f32_bf16 v202, v100, v253, 0
    v_dot2_f32_bf16 v222, v100, v100, 0
    s_waitcnt vmcnt(21)
    v_dot2_f32_bf16 v203, v108, v253, 0
    v_dot2_f32_bf16 v223, v108, v108, 0
    v_dot2c_f32_bf16 v202, v101, v253
    v_dot2c_f32_bf16 v222, v101, v101
    v_dot2c_f32_bf16 v203, v109, v253
    v_dot2c_f32_bf16 v223, v109, v109
    v_dot2c_f32_bf16 v202, v102, v253
    v_dot2c_f32_bf16 v222, v102, v102
    v_dot2c_f32_bf16 v203, v110, v253
    buffer_load_dwordx4 v9, s[16:19], s28 offen offset:2048 lds
    v_dot2c_f32_bf16 v223, v110, v110
    v_dot2c_f32_bf16 v202, v103, v253
    v_dot2c_f32_bf16 v222, v103, v103
    v_dot2c_f32_bf16 v203, v111, v253
    v_dot2c_f32_bf16 v223, v111, v111
    s_waitcnt vmcnt(21)
    v_dot2_f32_bf16 v204, v116, v253, 0
    v_dot2_f32_bf16 v224, v116, v116, 0
    s_waitcnt vmcnt(20)
    v_dot2_f32_bf16 v205, v124, v253, 0
    v_dot2_f32_bf16 v225, v124, v124, 0
    v_dot2c_f32_bf16 v204, v117, v253
    v_dot2c_f32_bf16 v224, v117, v117
    v_dot2c_f32_bf16 v205, v125, v253
    v_dot2c_f32_bf16 v225, v125, v125
    v_dot2c_f32_bf16 v204, v118, v253
    v_dot2c_f32_bf16 v224, v118, v118
    v_dot2c_f32_bf16 v205, v126, v253
    v_dot2c_f32_bf16 v225, v126, v126
    v_dot2c_f32_bf16 v204, v119, v253
    s_add_u32 s28, s34, 393216
    s_add_u32 m0, s35, 131072
    s_nop 0
    buffer_load_dwordx4 v8, s[16:19], s28 offen offset:0 lds
    v_dot2c_f32_bf16 v224, v119, v119
    v_dot2c_f32_bf16 v205, v127, v253
    v_dot2c_f32_bf16 v225, v127, v127
    s_waitcnt vmcnt(20)
    v_dot2_f32_bf16 v206, v132, v253, 0
    v_dot2_f32_bf16 v226, v132, v132, 0
    s_waitcnt vmcnt(19)
    v_dot2_f32_bf16 v207, v140, v253, 0
    v_dot2_f32_bf16 v227, v140, v140, 0
    v_dot2c_f32_bf16 v206, v133, v253
    v_dot2c_f32_bf16 v226, v133, v133
    v_dot2c_f32_bf16 v207, v141, v253
    v_dot2c_f32_bf16 v227, v141, v141
    v_dot2c_f32_bf16 v206, v134, v253
    v_dot2c_f32_bf16 v226, v134, v134
    v_dot2c_f32_bf16 v207, v142, v253
    v_dot2c_f32_bf16 v227, v142, v142
    v_dot2c_f32_bf16 v206, v135, v253
    v_dot2c_f32_bf16 v226, v135, v135
    v_dot2c_f32_bf16 v207, v143, v253
    v_dot2c_f32_bf16 v227, v143, v143
    buffer_load_dwordx4 v8, s[16:19], s28 offen offset:1024 lds
    s_waitcnt vmcnt(19)
    v_dot2_f32_bf16 v208, v148, v253, 0
    v_dot2_f32_bf16 v228, v148, v148, 0
    s_waitcnt vmcnt(18)
    v_dot2_f32_bf16 v209, v156, v253, 0
    v_dot2_f32_bf16 v229, v156, v156, 0
    v_dot2c_f32_bf16 v208, v149, v253
    v_dot2c_f32_bf16 v228, v149, v149
    v_dot2c_f32_bf16 v209, v157, v253
    v_dot2c_f32_bf16 v229, v157, v157
    v_dot2c_f32_bf16 v208, v150, v253
    v_dot2c_f32_bf16 v228, v150, v150
    v_dot2c_f32_bf16 v209, v158, v253
    v_dot2c_f32_bf16 v229, v158, v158
    v_dot2c_f32_bf16 v208, v151, v253
    v_dot2c_f32_bf16 v228, v151, v151
    v_dot2c_f32_bf16 v209, v159, v253
    v_dot2c_f32_bf16 v229, v159, v159
    s_waitcnt vmcnt(17)
    v_dot2_f32_bf16 v210, v164, v253, 0
    v_dot2_f32_bf16 v230, v164, v164, 0
    buffer_load_dwordx4 v8, s[16:19], s28 offen offset:2048 lds
    s_waitcnt vmcnt(17)
    v_dot2_f32_bf16 v211, v172, v253, 0
    v_dot2_f32_bf16 v231, v172, v172, 0
    v_dot2c_f32_bf16 v210, v165, v253
    v_dot2c_f32_bf16 v230, v165, v165
    v_dot2c_f32_bf16 v211, v173, v253
    v_dot2c_f32_bf16 v231, v173, v173
    v_dot2c_f32_bf16 v210, v166, v253
    v_dot2c_f32_bf16 v230, v166, v166
    v_dot2c_f32_bf16 v211, v174, v253
    v_dot2c_f32_bf16 v231, v174, v174
    v_dot2c_f32_bf16 v210, v167, v253
    v_dot2c_f32_bf16 v230, v167, v167
    v_dot2c_f32_bf16 v211, v175, v253
    v_dot2c_f32_bf16 v231, v175, v175
    v_permlane32_swap_b32 v192, v212
    v_permlane32_swap_b32 v193, v213
    v_permlane32_swap_b32 v194, v214
    v_permlane32_swap_b32 v195, v215
    s_add_u32 s28, s34, 417792
    s_add_u32 m0, s35, 134144
    s_nop 0
    buffer_load_dwordx4 v9, s[16:19], s28 offen offset:0 lds
    v_permlane32_swap_b32 v196, v216
    v_permlane32_swap_b32 v197, v217
    v_permlane32_swap_b32 v198, v218
    v_permlane32_swap_b32 v199, v219
    v_permlane32_swap_b32 v200, v220
    v_permlane32_swap_b32 v201, v221
    v_permlane32_swap_b32 v202, v222
    v_permlane32_swap_b32 v203, v223
    v_permlane32_swap_b32 v204, v224
    v_permlane32_swap_b32 v205, v225
    v_permlane32_swap_b32 v206, v226
    v_permlane32_swap_b32 v207, v227
    v_permlane32_swap_b32 v208, v228
    v_permlane32_swap_b32 v209, v229
    v_permlane32_swap_b32 v210, v230
    v_permlane32_swap_b32 v211, v231
    v_add_f32 v192, v192, v212
    v_add_f32 v193, v193, v213
    buffer_load_dwordx4 v9, s[16:19], s28 offen offset:1024 lds
    v_add_f32 v194, v194, v214
    v_add_f32 v195, v195, v215
    v_add_f32 v196, v196, v216
    v_add_f32 v197, v197, v217
    v_add_f32 v198, v198, v218
    v_add_f32 v199, v199, v219
    v_add_f32 v200, v200, v220
    v_add_f32 v201, v201, v221
    v_add_f32 v202, v202, v222
    v_add_f32 v203, v203, v223
    v_add_f32 v204, v204, v224
    v_add_f32 v205, v205, v225
    v_add_f32 v206, v206, v226
    v_add_f32 v207, v207, v227
    v_add_f32 v208, v208, v228
    v_add_f32 v209, v209, v229
    v_add_f32 v210, v210, v230
    v_add_f32 v211, v211, v231
    v_permlane16_swap_b32 v192, v193
    buffer_load_dwordx4 v9, s[16:19], s28 offen offset:2048 lds
    v_permlane16_swap_b32 v194, v195
    v_permlane16_swap_b32 v196, v197
    v_permlane16_swap_b32 v198, v199
    v_permlane16_swap_b32 v200, v201
    v_permlane16_swap_b32 v202, v203
    v_permlane16_swap_b32 v204, v205
    v_permlane16_swap_b32 v206, v207
    v_permlane16_swap_b32 v208, v209
    v_permlane16_swap_b32 v210, v211
    v_add_f32 v212, v192, v193
    v_add_f32 v213, v194, v195
    v_add_f32 v214, v196, v197
    v_add_f32 v215, v198, v199
    v_add_f32 v216, v200, v201
    v_add_f32 v217, v202, v203
    v_add_f32 v218, v204, v205
    v_add_f32 v219, v206, v207
    v_add_f32 v220, v208, v209
    s_add_u32 s28, s34, 589824
    s_add_u32 m0, s35, 8192
    s_nop 0
    buffer_load_dwordx4 v8, s[16:19], s28 offen offset:0 lds
    v_add_f32 v221, v210, v211
    v_add_f32_dpp v200, v212, v212 row_ror:8 row_mask:0xf bank_mask:0x3
    v_add_f32_dpp v201, v214, v214 row_ror:8 row_mask:0xf bank_mask:0x3
    v_add_f32_dpp v202, v216, v216 row_ror:8 row_mask:0xf bank_mask:0x3
    v_add_f32_dpp v203, v218, v218 row_ror:8 row_mask:0xf bank_mask:0x3
    v_add_f32_dpp v204, v220, v220 row_ror:8 row_mask:0xf bank_mask:0x3
    v_add_f32_dpp v200, v213, v213 row_ror:8 row_mask:0xf bank_mask:0xc
    v_add_f32_dpp v201, v215, v215 row_ror:8 row_mask:0xf bank_mask:0xc
    v_add_f32_dpp v202, v217, v217 row_ror:8 row_mask:0xf bank_mask:0xc
    v_add_f32_dpp v203, v219, v219 row_ror:8 row_mask:0xf bank_mask:0xc
    v_add_f32_dpp v204, v221, v221 row_ror:8 row_mask:0xf bank_mask:0xc
    v_add_f32_dpp v192, v200, v200 row_shl:4 row_mask:0xf bank_mask:0x5
    v_add_f32_dpp v193, v202, v202 row_shl:4 row_mask:0xf bank_mask:0x5
    v_add_f32_dpp v194, v204, v204 row_shl:4 row_mask:0xf bank_mask:0x5
    v_add_f32_dpp v192, v201, v201 row_shr:4 row_mask:0xf bank_mask:0xa
    v_add_f32_dpp v193, v203, v203 row_shr:4 row_mask:0xf bank_mask:0xa
    s_nop 0
    v_add_f32_dpp v192, v192, v192 quad_perm:[1,0,3,2] row_mask:0xf bank_mask:0xf
    v_add_f32_dpp v193, v193, v193 quad_perm:[1,0,3,2] row_mask:0xf bank_mask:0xf
    buffer_load_dwordx4 v8, s[16:19], s28 offen offset:1024 lds
    v_add_f32_dpp v194, v194, v194 quad_perm:[1,0,3,2] row_mask:0xf bank_mask:0xf
    v_add_f32_dpp v192, v192, v192 quad_perm:[2,3,0,1] row_mask:0xf bank_mask:0xf
    v_add_f32_dpp v193, v193, v193 quad_perm:[2,3,0,1] row_mask:0xf bank_mask:0xf
    v_add_f32_dpp v194, v194, v194 quad_perm:[2,3,0,1] row_mask:0xf bank_mask:0xf
    v_mov_b32 v196, v192
    v_mov_b32 v197, v193
    v_mov_b32 v198, v194
    v_permlane32_swap_b32 v196, v192
    v_permlane32_swap_b32 v197, v193
    v_permlane32_swap_b32 v198, v194
    v_mul_f32 v196, 0x3b000000, v196
    v_mul_f32 v197, 0x3b000000, v197
    v_mul_f32 v198, 0x3b000000, v198
    v_mul_f32 v192, 0x3b000000, v192
    v_mul_f32 v193, 0x3b000000, v193
    v_mul_f32 v194, 0x3b000000, v194
    v_fma_f32 v192, -v196, v196, v192
    v_fma_f32 v193, -v197, v197, v193
    v_fma_f32 v194, -v198, v198, v194
    buffer_load_dwordx4 v8, s[16:19], s28 offen offset:2048 lds
    v_max_f32 v192, 0, v192
    v_max_f32 v193, 0, v193
    v_max_f32 v194, 0, v194
    v_add_f32 v192, 0x3727c5ac, v192
    v_add_f32 v193, 0x3727c5ac, v193
    v_add_f32 v194, 0x3727c5ac, v194
    v_rsq_f32 v192, v192
    v_rsq_f32 v193, v193
    v_rsq_f32 v194, v194
    v_mul_f32 v196, -v196, v192
    v_mul_f32 v197, -v197, v193
    v_mul_f32 v198, -v198, v194
    v_readlane_b32 s56, v192, 0
    v_readlane_b32 s57, v196, 0
    v_lshlrev_b32 v16, 16, v20
    v_and_b32 v17, s7, v20
    v_lshlrev_b32 v18, 16, v21
    v_and_b32 v19, s7, v21
    s_add_u32 s28, s34, 614400
    s_add_u32 m0, s35, 11264
    s_nop 0
    buffer_load_dwordx4 v9, s[16:19], s28 offen offset:0 lds
    v_lshlrev_b32 v20, 16, v22
    v_and_b32 v21, s7, v22
    v_lshlrev_b32 v22, 16, v23
    v_and_b32 v23, s7, v23
    v_pk_fma_f32 v[16:17], v[16:17], s[56:57], s[56:57] op_sel:[0,0,1] op_sel_hi:[1,0,1]
    v_pk_fma_f32 v[18:19], v[18:19], s[56:57], s[56:57] op_sel:[0,0,1] op_sel_hi:[1,0,1]
    v_pk_fma_f32 v[20:21], v[20:21], s[56:57], s[56:57] op_sel:[0,0,1] op_sel_hi:[1,0,1]
    v_pk_fma_f32 v[22:23], v[22:23], s[56:57], s[56:57] op_sel:[0,0,1] op_sel_hi:[1,0,1]
    v_readlane_b32 s58, v192, 16
    v_readlane_b32 s59, v196, 16
    v_lshlrev_b32 v24, 16, v28
    v_and_b32 v25, s7, v28
    v_lshlrev_b32 v26, 16, v29
    v_and_b32 v27, s7, v29
    v_lshlrev_b32 v28, 16, v30
    v_and_b32 v29, s7, v30
    v_lshlrev_b32 v30, 16, v31
    v_and_b32 v31, s7, v31
    buffer_load_dwordx4 v9, s[16:19], s28 offen offset:1024 lds
    v_pk_fma_f32 v[24:25], v[24:25], s[58:59], s[58:59] op_sel:[0,0,1] op_sel_hi:[1,0,1]
    v_pk_fma_f32 v[26:27], v[26:27], s[58:59], s[58:59] op_sel:[0,0,1] op_sel_hi:[1,0,1]
    v_pk_fma_f32 v[28:29], v[28:29], s[58:59], s[58:59] op_sel:[0,0,1] op_sel_hi:[1,0,1]
    v_pk_fma_f32 v[30:31], v[30:31], s[58:59], s[58:59] op_sel:[0,0,1] op_sel_hi:[1,0,1]
    v_readlane_b32 s56, v192, 8
    v_readlane_b32 s57, v196, 8
    v_lshlrev_b32 v32, 16, v36
    v_and_b32 v33, s7, v36
    v_lshlrev_b32 v34, 16, v37
    v_and_b32 v35, s7, v37
    v_lshlrev_b32 v36, 16, v38
    v_and_b32 v37, s7, v38
    v_lshlrev_b32 v38, 16, v39
    v_and_b32 v39, s7, v39
    v_pk_fma_f32 v[32:33], v[32:33], s[56:57], s[56:57] op_sel:[0,0,1] op_sel_hi:[1,0,1]
    v_pk_fma_f32 v[34:35], v[34:35], s[56:57], s[56:57] op_sel:[0,0,1] op_sel_hi:[1,0,1]
    v_pk_fma_f32 v[36:37], v[36:37], s[56:57], s[56:57] op_sel:[0,0,1] op_sel_hi:[1,0,1]
    v_pk_fma_f32 v[38:39], v[38:39], s[56:57], s[56:57] op_sel:[0,0,1] op_sel_hi:[1,0,1]
    v_readlane_b32 s58, v192, 24
    buffer_load_dwordx4 v9, s[16:19], s28 offen offset:2048 lds
    v_readlane_b32 s59, v196, 24
    v_lshlrev_b32 v40, 16, v44
    v_and_b32 v41, s7, v44
    v_lshlrev_b32 v42, 16, v45
    v_and_b32 v43, s7, v45
    v_lshlrev_b32 v44, 16, v46
    v_and_b32 v45, s7, v46
    v_lshlrev_b32 v46, 16, v47
    v_and_b32 v47, s7, v47
    v_pk_fma_f32 v[40:41], v[40:41], s[58:59], s[58:59] op_sel:[0,0,1] op_sel_hi:[1,0,1]
    v_pk_fma_f32 v[42:43], v[42:43], s[58:59], s[58:59] op_sel:[0,0,1] op_sel_hi:[1,0,1]
    v_pk_fma_f32 v[44:45], v[44:45], s[58:59], s[58:59] op_sel:[0,0,1] op_sel_hi:[1,0,1]
    v_pk_fma_f32 v[46:47], v[46:47], s[58:59], s[58:59] op_sel:[0,0,1] op_sel_hi:[1,0,1]
    v_readlane_b32 s56, v192, 4
    v_readlane_b32 s57, v196, 4
    v_lshlrev_b32 v48, 16, v52
    v_and_b32 v49, s7, v52
    v_lshlrev_b32 v50, 16, v53
    s_add_u32 s28, s34, 786432
    s_add_u32 m0, s35, 32768
    s_nop 0
    buffer_load_dwordx4 v8, s[16:19], s28 offen offset:0 lds
    v_and_b32 v51, s7, v53
    v_lshlrev_b32 v52, 16, v54
    v_and_b32 v53, s7, v54
    v_lshlrev_b32 v54, 16, v55
    v_and_b32 v55, s7, v55
    v_pk_fma_f32 v[48:49], v[48:49], s[56:57], s[56:57] op_sel:[0,0,1] op_sel_hi:[1,0,1]
    v_pk_fma_f32 v[50:51], v[50:51], s[56:57], s[56:57] op_sel:[0,0,1] op_sel_hi:[1,0,1]
    v_pk_fma_f32 v[52:53], v[52:53], s[56:57], s[56:57] op_sel:[0,0,1] op_sel_hi:[1,0,1]
    v_pk_fma_f32 v[54:55], v[54:55], s[56:57], s[56:57] op_sel:[0,0,1] op_sel_hi:[1,0,1]
    v_readlane_b32 s58, v192, 20
    v_readlane_b32 s59, v196, 20
    v_lshlrev_b32 v56, 16, v60
    v_and_b32 v57, s7, v60
    v_lshlrev_b32 v58, 16, v61
    v_and_b32 v59, s7, v61
    v_lshlrev_b32 v60, 16, v62
    v_and_b32 v61, s7, v62
    v_lshlrev_b32 v62, 16, v63
    buffer_load_dwordx4 v8, s[16:19], s28 offen offset:1024 lds
    v_and_b32 v63, s7, v63
    v_pk_fma_f32 v[56:57], v[56:57], s[58:59], s[58:59] op_sel:[0,0,1] op_sel_hi:[1,0,1]
    v_pk_fma_f32 v[58:59], v[58:59], s[58:59], s[58:59] op_sel:[0,0,1] op_sel_hi:[1,0,1]
    v_pk_fma_f32 v[60:61], v[60:61], s[58:59], s[58:59] op_sel:[0,0,1] op_sel_hi:[1,0,1]
    v_pk_fma_f32 v[62:63], v[62:63], s[58:59], s[58:59] op_sel:[0,0,1] op_sel_hi:[1,0,1]
    v_readlane_b32 s56, v192, 12
    v_readlane_b32 s57, v196, 12
    v_lshlrev_b32 v64, 16, v68
    v_and_b32 v65, s7, v68
    v_lshlrev_b32 v66, 16, v69
    v_and_b32 v67, s7, v69
    v_lshlrev_b32 v68, 16, v70
    v_and_b32 v69, s7, v70
    v_lshlrev_b32 v70, 16, v71
    v_and_b32 v71, s7, v71
    v_pk_fma_f32 v[64:65], v[64:65], s[56:57], s[56:57] op_sel:[0,0,1] op_sel_hi:[1,0,1]
    v_pk_fma_f32 v[66:67], v[66:67], s[56:57], s[56:57] op_sel:[0,0,1] op_sel_hi:[1,0,1]
    v_pk_fma_f32 v[68:69], v[68:69], s[56:57], s[56:57] op_sel:[0,0,1] op_sel_hi:[1,0,1]
    buffer_load_dwordx4 v8, s[16:19], s28 offen offset:2048 lds
    v_pk_fma_f32 v[70:71], v[70:71], s[56:57], s[56:57] op_sel:[0,0,1] op_sel_hi:[1,0,1]
    v_readlane_b32 s58, v192, 28
    v_readlane_b32 s59, v196, 28
    v_lshlrev_b32 v72, 16, v76
    v_and_b32 v73, s7, v76
    v_lshlrev_b32 v74, 16, v77
    v_and_b32 v75, s7, v77
    v_lshlrev_b32 v76, 16, v78
    v_and_b32 v77, s7, v78
    v_lshlrev_b32 v78, 16, v79
    v_and_b32 v79, s7, v79
    v_pk_fma_f32 v[72:73], v[72:73], s[58:59], s[58:59] op_sel:[0,0,1] op_sel_hi:[1,0,1]
    v_pk_fma_f32 v[74:75], v[74:75], s[58:59], s[58:59] op_sel:[0,0,1] op_sel_hi:[1,0,1]
    v_pk_fma_f32 v[76:77], v[76:77], s[58:59], s[58:59] op_sel:[0,0,1] op_sel_hi:[1,0,1]
    v_pk_fma_f32 v[78:79], v[78:79], s[58:59], s[58:59] op_sel:[0,0,1] op_sel_hi:[1,0,1]
    v_readlane_b32 s56, v193, 0
    v_readlane_b32 s57, v197, 0
    v_lshlrev_b32 v80, 16, v84
    v_and_b32 v81, s7, v84
    s_add_u32 s28, s34, 811008
    s_add_u32 m0, s35, 35840
    s_nop 0
    buffer_load_dwordx4 v9, s[16:19], s28 offen offset:0 lds
    v_lshlrev_b32 v82, 16, v85
    v_and_b32 v83, s7, v85
    v_lshlrev_b32 v84, 16, v86
    v_and_b32 v85, s7, v86
    v_lshlrev_b32 v86, 16, v87
    v_and_b32 v87, s7, v87
    v_pk_fma_f32 v[80:81], v[80:81], s[56:57], s[56:57] op_sel:[0,0,1] op_sel_hi:[1,0,1]
    v_pk_fma_f32 v[82:83], v[82:83], s[56:57], s[56:57] op_sel:[0,0,1] op_sel_hi:[1,0,1]
    v_pk_fma_f32 v[84:85], v[84:85], s[56:57], s[56:57] op_sel:[0,0,1] op_sel_hi:[1,0,1]
    v_pk_fma_f32 v[86:87], v[86:87], s[56:57], s[56:57] op_sel:[0,0,1] op_sel_hi:[1,0,1]
    v_readlane_b32 s58, v193, 16
    v_readlane_b32 s59, v197, 16
    v_lshlrev_b32 v88, 16, v92
    v_and_b32 v89, s7, v92
    v_lshlrev_b32 v90, 16, v93
    v_and_b32 v91, s7, v93
    v_lshlrev_b32 v92, 16, v94
    v_and_b32 v93, s7, v94
    buffer_load_dwordx4 v9, s[16:19], s28 offen offset:1024 lds
    v_lshlrev_b32 v94, 16, v95
    v_and_b32 v95, s7, v95
    v_pk_fma_f32 v[88:89], v[88:89], s[58:59], s[58:59] op_sel:[0,0,1] op_sel_hi:[1,0,1]
    v_pk_fma_f32 v[90:91], v[90:91], s[58:59], s[58:59] op_sel:[0,0,1] op_sel_hi:[1,0,1]
    v_pk_fma_f32 v[92:93], v[92:93], s[58:59], s[58:59] op_sel:[0,0,1] op_sel_hi:[1,0,1]
    v_pk_fma_f32 v[94:95], v[94:95], s[58:59], s[58:59] op_sel:[0,0,1] op_sel_hi:[1,0,1]
    v_readlane_b32 s56, v193, 8
    v_readlane_b32 s57, v197, 8
    v_lshlrev_b32 v96, 16, v100
    v_and_b32 v97, s7, v100
    v_lshlrev_b32 v98, 16, v101
    v_and_b32 v99, s7, v101
    v_lshlrev_b32 v100, 16, v102
    v_and_b32 v101, s7, v102
    v_lshlrev_b32 v102, 16, v103
    v_and_b32 v103, s7, v103
    v_pk_fma_f32 v[96:97], v[96:97], s[56:57], s[56:57] op_sel:[0,0,1] op_sel_hi:[1,0,1]
    v_pk_fma_f32 v[98:99], v[98:99], s[56:57], s[56:57] op_sel:[0,0,1] op_sel_hi:[1,0,1]
    buffer_load_dwordx4 v9, s[16:19], s28 offen offset:2048 lds
    v_pk_fma_f32 v[100:101], v[100:101], s[56:57], s[56:57] op_sel:[0,0,1] op_sel_hi:[1,0,1]
    v_pk_fma_f32 v[102:103], v[102:103], s[56:57], s[56:57] op_sel:[0,0,1] op_sel_hi:[1,0,1]
    v_readlane_b32 s58, v193, 24
    v_readlane_b32 s59, v197, 24
    v_lshlrev_b32 v104, 16, v108
    v_and_b32 v105, s7, v108
    v_lshlrev_b32 v106, 16, v109
    v_and_b32 v107, s7, v109
    v_lshlrev_b32 v108, 16, v110
    v_and_b32 v109, s7, v110
    v_lshlrev_b32 v110, 16, v111
    v_and_b32 v111, s7, v111
    v_pk_fma_f32 v[104:105], v[104:105], s[58:59], s[58:59] op_sel:[0,0,1] op_sel_hi:[1,0,1]
    v_pk_fma_f32 v[106:107], v[106:107], s[58:59], s[58:59] op_sel:[0,0,1] op_sel_hi:[1,0,1]
    v_pk_fma_f32 v[108:109], v[108:109], s[58:59], s[58:59] op_sel:[0,0,1] op_sel_hi:[1,0,1]
    v_pk_fma_f32 v[110:111], v[110:111], s[58:59], s[58:59] op_sel:[0,0,1] op_sel_hi:[1,0,1]
    v_readlane_b32 s56, v193, 4
    v_readlane_b32 s57, v197, 4
    v_lshlrev_b32 v112, 16, v116
    s_add_u32 s28, s34, 983040
    s_add_u32 m0, s35, 57344
    s_nop 0
    buffer_load_dwordx4 v8, s[16:19], s28 offen offset:0 lds
    v_and_b32 v113, s7, v116
    v_lshlrev_b32 v114, 16, v117
    v_and_b32 v115, s7, v117
    v_lshlrev_b32 v116, 16, v118
    v_and_b32 v117, s7, v118
    v_lshlrev_b32 v118, 16, v119
    v_and_b32 v119, s7, v119
    v_pk_fma_f32 v[112:113], v[112:113], s[56:57], s[56:57] op_sel:[0,0,1] op_sel_hi:[1,0,1]
    v_pk_fma_f32 v[114:115], v[114:115], s[56:57], s[56:57] op_sel:[0,0,1] op_sel_hi:[1,0,1]
    v_pk_fma_f32 v[116:117], v[116:117], s[56:57], s[56:57] op_sel:[0,0,1] op_sel_hi:[1,0,1]
    v_pk_fma_f32 v[118:119], v[118:119], s[56:57], s[56:57] op_sel:[0,0,1] op_sel_hi:[1,0,1]
    v_readlane_b32 s58, v193, 20
    v_readlane_b32 s59, v197, 20
    v_lshlrev_b32 v120, 16, v124
    v_and_b32 v121, s7, v124
    v_lshlrev_b32 v122, 16, v125
    v_and_b32 v123, s7, v125
    v_lshlrev_b32 v124, 16, v126
    buffer_load_dwordx4 v8, s[16:19], s28 offen offset:1024 lds
    v_and_b32 v125, s7, v126
    v_lshlrev_b32 v126, 16, v127
    v_and_b32 v127, s7, v127
    v_pk_fma_f32 v[120:121], v[120:121], s[58:59], s[58:59] op_sel:[0,0,1] op_sel_hi:[1,0,1]
    v_pk_fma_f32 v[122:123], v[122:123], s[58:59], s[58:59] op_sel:[0,0,1] op_sel_hi:[1,0,1]
    v_pk_fma_f32 v[124:125], v[124:125], s[58:59], s[58:59] op_sel:[0,0,1] op_sel_hi:[1,0,1]
    v_pk_fma_f32 v[126:127], v[126:127], s[58:59], s[58:59] op_sel:[0,0,1] op_sel_hi:[1,0,1]
    v_readlane_b32 s56, v193, 12
    v_readlane_b32 s57, v197, 12
    v_lshlrev_b32 v128, 16, v132
    v_and_b32 v129, s7, v132
    v_lshlrev_b32 v130, 16, v133
    v_and_b32 v131, s7, v133
    v_lshlrev_b32 v132, 16, v134
    v_and_b32 v133, s7, v134
    v_lshlrev_b32 v134, 16, v135
    v_and_b32 v135, s7, v135
    v_pk_fma_f32 v[128:129], v[128:129], s[56:57], s[56:57] op_sel:[0,0,1] op_sel_hi:[1,0,1]
    buffer_load_dwordx4 v8, s[16:19], s28 offen offset:2048 lds
    v_pk_fma_f32 v[130:131], v[130:131], s[56:57], s[56:57] op_sel:[0,0,1] op_sel_hi:[1,0,1]
    v_pk_fma_f32 v[132:133], v[132:133], s[56:57], s[56:57] op_sel:[0,0,1] op_sel_hi:[1,0,1]
    v_pk_fma_f32 v[134:135], v[134:135], s[56:57], s[56:57] op_sel:[0,0,1] op_sel_hi:[1,0,1]
    v_readlane_b32 s58, v193, 28
    v_readlane_b32 s59, v197, 28
    v_lshlrev_b32 v136, 16, v140
    v_and_b32 v137, s7, v140
    v_lshlrev_b32 v138, 16, v141
    v_and_b32 v139, s7, v141
    v_lshlrev_b32 v140, 16, v142
    v_and_b32 v141, s7, v142
    v_lshlrev_b32 v142, 16, v143
    v_and_b32 v143, s7, v143
    v_pk_fma_f32 v[136:137], v[136:137], s[58:59], s[58:59] op_sel:[0,0,1] op_sel_hi:[1,0,1]
    v_pk_fma_f32 v[138:139], v[138:139], s[58:59], s[58:59] op_sel:[0,0,1] op_sel_hi:[1,0,1]
    v_pk_fma_f32 v[140:141], v[140:141], s[58:59], s[58:59] op_sel:[0,0,1] op_sel_hi:[1,0,1]
    v_pk_fma_f32 v[142:143], v[142:143], s[58:59], s[58:59] op_sel:[0,0,1] op_sel_hi:[1,0,1]
    v_readlane_b32 s56, v194, 0
    v_readlane_b32 s57, v198, 0
    s_add_u32 s28, s34, 1007616
    s_add_u32 m0, s35, 60416
    s_nop 0
    buffer_load_dwordx4 v9, s[16:19], s28 offen offset:0 lds
    v_lshlrev_b32 v144, 16, v148
    v_and_b32 v145, s7, v148
    v_lshlrev_b32 v146, 16, v149
    v_and_b32 v147, s7, v149
    v_lshlrev_b32 v148, 16, v150
    v_and_b32 v149, s7, v150
    v_lshlrev_b32 v150, 16, v151
    v_and_b32 v151, s7, v151
    v_pk_fma_f32 v[144:145], v[144:145], s[56:57], s[56:57] op_sel:[0,0,1] op_sel_hi:[1,0,1]
    v_pk_fma_f32 v[146:147], v[146:147], s[56:57], s[56:57] op_sel:[0,0,1] op_sel_hi:[1,0,1]
    v_pk_fma_f32 v[148:149], v[148:149], s[56:57], s[56:57] op_sel:[0,0,1] op_sel_hi:[1,0,1]
    v_pk_fma_f32 v[150:151], v[150:151], s[56:57], s[56:57] op_sel:[0,0,1] op_sel_hi:[1,0,1]
    v_readlane_b32 s58, v194, 16
    v_readlane_b32 s59, v198, 16
    v_lshlrev_b32 v152, 16, v156
    v_and_b32 v153, s7, v156
    v_lshlrev_b32 v154, 16, v157
    v_and_b32 v155, s7, v157
    buffer_load_dwordx4 v9, s[16:19], s28 offen offset:1024 lds
    v_lshlrev_b32 v156, 16, v158
    v_and_b32 v157, s7, v158
    v_lshlrev_b32 v158, 16, v159
    v_and_b32 v159, s7, v159
    v_pk_fma_f32 v[152:153], v[152:153], s[58:59], s[58:59] op_sel:[0,0,1] op_sel_hi:[1,0,1]
    v_pk_fma_f32 v[154:155], v[154:155], s[58:59], s[58:59] op_sel:[0,0,1] op_sel_hi:[1,0,1]
    v_pk_fma_f32 v[156:157], v[156:157], s[58:59], s[58:59] op_sel:[0,0,1] op_sel_hi:[1,0,1]
    v_pk_fma_f32 v[158:159], v[158:159], s[58:59], s[58:59] op_sel:[0,0,1] op_sel_hi:[1,0,1]
    v_readlane_b32 s56, v194, 8
    v_readlane_b32 s57, v198, 8
    v_lshlrev_b32 v160, 16, v164
    v_and_b32 v161, s7, v164
    v_lshlrev_b32 v162, 16, v165
    v_and_b32 v163, s7, v165
    v_lshlrev_b32 v164, 16, v166
    v_and_b32 v165, s7, v166
    v_lshlrev_b32 v166, 16, v167
    v_and_b32 v167, s7, v167
    buffer_load_dwordx4 v9, s[16:19], s28 offen offset:2048 lds
    v_pk_fma_f32 v[160:161], v[160:161], s[56:57], s[56:57] op_sel:[0,0,1] op_sel_hi:[1,0,1]
    v_pk_fma_f32 v[162:163], v[162:163], s[56:57], s[56:57] op_sel:[0,0,1] op_sel_hi:[1,0,1]
    v_pk_fma_f32 v[164:165], v[164:165], s[56:57], s[56:57] op_sel:[0,0,1] op_sel_hi:[1,0,1]
    v_pk_fma_f32 v[166:167], v[166:167], s[56:57], s[56:57] op_sel:[0,0,1] op_sel_hi:[1,0,1]
    v_readlane_b32 s58, v194, 24
    v_readlane_b32 s59, v198, 24
    v_lshlrev_b32 v168, 16, v172
    v_and_b32 v169, s7, v172
    v_lshlrev_b32 v170, 16, v173
    v_and_b32 v171, s7, v173
    v_lshlrev_b32 v172, 16, v174
    v_and_b32 v173, s7, v174
    v_lshlrev_b32 v174, 16, v175
    v_and_b32 v175, s7, v175
    v_pk_fma_f32 v[168:169], v[168:169], s[58:59], s[58:59] op_sel:[0,0,1] op_sel_hi:[1,0,1]
    v_pk_fma_f32 v[170:171], v[170:171], s[58:59], s[58:59] op_sel:[0,0,1] op_sel_hi:[1,0,1]
    v_pk_fma_f32 v[172:173], v[172:173], s[58:59], s[58:59] op_sel:[0,0,1] op_sel_hi:[1,0,1]
    v_pk_fma_f32 v[174:175], v[174:175], s[58:59], s[58:59] op_sel:[0,0,1] op_sel_hi:[1,0,1]
    v_lshlrev_b32 v4, 5, v0
    s_lshl_b32 s24, s3, 11
    s_add_u32 s36, s24, 262144
    v_lshlrev_b32 v5, 3, v0
    s_add_u32 s24, s3, 2
    s_lshl_b32 s24, s24, 9
    s_lshl_b32 s25, s5, 6
    s_add_u32 s24, s24, s25
    s_lshl_b32 s24, s24, 3
    s_add_u32 s37, s24, 262144
    v_bfe_u32 v6, v0, 3, 2
    v_lshlrev_b32 v6, 7, v6
    v_and_b32 v7, 7, v0
    v_lshl_add_u32 v6, v7, 2, v6
    s_and_b32 s24, s2, 7
    s_lshl_b32 s24, s24, 9
    s_add_u32 s38, s24, 36864
    s_and_b32 s39, s96, 0x0fffffff
    buffer_load_dwordx4 v[176:179], v4, s[12:15], s36 offen sc1
    buffer_load_dwordx4 v[180:183], v4, s[12:15], s36 offen offset:16 sc1
    buffer_load_dwordx2 v[184:185], v5, s[12:15], s37 offen sc1
    buffer_load_dword v186, v6, s[12:15], s38 offen sc1
    s_waitcnt vmcnt(34)
    s_waitcnt lgkmcnt(0)
    s_barrier
    v_add_u32 v11, 81920, v10
    v_and_b32 v12, 15, v0
    ds_read_b64_tr_b16 a[0:1], v11 offset:0
    v_lshrrev_b32 v13, 4, v0
    ds_read_b64_tr_b16 a[2:3], v11 offset:512
    ds_read_b64_tr_b16 a[4:5], v11 offset:12288
    v_lshlrev_b32 v13, 2, v13
    ds_read_b64_tr_b16 a[6:7], v11 offset:12800
    v_mov_b32 v2, 0xf149f2ca
    ds_read_b64_tr_b16 a[64:65], v11 offset:1024
    ds_read_b64_tr_b16 a[66:67], v11 offset:1536
    s_cmp_eq_u32 s4, 0
    s_cselect_b64 s[30:31], 0, -1
    ds_read_b64_tr_b16 a[68:69], v11 offset:13312
    v_add_u32 v14, 0, v13
    ds_read_b64_tr_b16 a[70:71], v11 offset:13824
    ds_read_b64_tr_b16 a[128:129], v11 offset:2048
    v_sub_u32 v15, v12, v14
    ds_read_b64_tr_b16 a[130:131], v11 offset:2560
    v_cmp_ge_u32 vcc, 7, v15
    ds_read_b64_tr_b16 a[132:133], v11 offset:14336
    ds_read_b64_tr_b16 a[134:135], v11 offset:14848
    v_cndmask_b32 v192, v2, 0, vcc
    s_waitcnt vmcnt(28)
    s_waitcnt lgkmcnt(0)
    s_barrier
    v_add_u32 v11, 106496, v10
    v_cmp_ge_i32 vcc, -9, v15
    s_add_u32 s28, s34, 1179648
    s_add_u32 m0, s35, 81920
    s_nop 0
    buffer_load_dwordx4 v8, s[16:19], s28 offen offset:0 lds
    ds_read_b64_tr_b16 a[8:9], v11 offset:0
    v_cndmask_b32 v196, v2, 0, vcc
    ds_read_b64_tr_b16 a[10:11], v11 offset:512
    buffer_load_dwordx4 v8, s[16:19], s28 offen offset:1024 lds
    s_and_b64 vcc, vcc, s[30:31]
    ds_read_b64_tr_b16 a[12:13], v11 offset:12288
    v_cndmask_b32 v204, v2, 0, vcc
    ds_read_b64_tr_b16 a[14:15], v11 offset:12800
    buffer_load_dwordx4 v8, s[16:19], s28 offen offset:2048 lds
    v_cmp_ge_i32 vcc, -1, v15
    ds_read_b64_tr_b16 a[72:73], v11 offset:1024
    v_cmp_ge_u32 s[26:27], 7, v14
    ds_read_b64_tr_b16 a[74:75], v11 offset:1536
    s_add_u32 s28, s34, 1204224
    s_add_u32 m0, s35, 84992
    s_nop 0
    buffer_load_dwordx4 v9, s[16:19], s28 offen offset:0 lds
    s_and_b64 vcc, vcc, s[26:27]
    ds_read_b64_tr_b16 a[76:77], v11 offset:13312
    s_and_b64 vcc, vcc, s[30:31]
    ds_read_b64_tr_b16 a[78:79], v11 offset:13824
    buffer_load_dwordx4 v9, s[16:19], s28 offen offset:1024 lds
    v_cndmask_b32 v200, v2, 0, vcc
    ds_read_b64_tr_b16 a[136:137], v11 offset:2048
    v_add_u32 v14, 1, v13
    ds_read_b64_tr_b16 a[138:139], v11 offset:2560
    buffer_load_dwordx4 v9, s[16:19], s28 offen offset:2048 lds
    v_sub_u32 v15, v12, v14
    ds_read_b64_tr_b16 a[140:141], v11 offset:14336
    v_cmp_ge_u32 vcc, 7, v15
    ds_read_b64_tr_b16 a[142:143], v11 offset:14848
    s_waitcnt vmcnt(28)
    s_waitcnt lgkmcnt(0)
    s_barrier
    v_add_u32 v11, 131072, v10
    v_cndmask_b32 v193, v2, 0, vcc
    s_add_u32 s28, s34, 1376256
    s_add_u32 m0, s35, 106496
    s_nop 0
    buffer_load_dwordx4 v8, s[16:19], s28 offen offset:0 lds
    ds_read_b64_tr_b16 a[16:17], v11 offset:0
    v_cmp_ge_i32 vcc, -9, v15
    ds_read_b64_tr_b16 a[18:19], v11 offset:512
    s_nop 0
    v_cndmask_b32 v197, v2, 0, vcc
    buffer_load_dwordx4 v8, s[16:19], s28 offen offset:1024 lds
    ds_read_b64_tr_b16 a[20:21], v11 offset:12288
    s_and_b64 vcc, vcc, s[30:31]
    ds_read_b64_tr_b16 a[22:23], v11 offset:12800
    v_cndmask_b32 v205, v2, 0, vcc
    buffer_load_dwordx4 v8, s[16:19], s28 offen offset:2048 lds
    ds_read_b64_tr_b16 a[80:81], v11 offset:1024
    v_cmp_ge_i32 vcc, -1, v15
    ds_read_b64_tr_b16 a[82:83], v11 offset:1536
    v_cmp_ge_u32 s[26:27], 7, v14
    s_add_u32 s28, s34, 1400832
    s_add_u32 m0, s35, 109568
    s_nop 0
    buffer_load_dwordx4 v9, s[16:19], s28 offen offset:0 lds
    ds_read_b64_tr_b16 a[84:85], v11 offset:13312
    s_and_b64 vcc, vcc, s[26:27]
    ds_read_b64_tr_b16 a[86:87], v11 offset:13824
    s_and_b64 vcc, vcc, s[30:31]
    buffer_load_dwordx4 v9, s[16:19], s28 offen offset:1024 lds
    ds_read_b64_tr_b16 a[144:145], v11 offset:2048
    v_cndmask_b32 v201, v2, 0, vcc
    ds_read_b64_tr_b16 a[146:147], v11 offset:2560
    v_add_u32 v14, 2, v13
    buffer_load_dwordx4 v9, s[16:19], s28 offen offset:2048 lds
    ds_read_b64_tr_b16 a[148:149], v11 offset:14336
    v_sub_u32 v15, v12, v14
    ds_read_b64_tr_b16 a[150:151], v11 offset:14848
    s_waitcnt vmcnt(28)
    s_waitcnt lgkmcnt(0)
    s_barrier
    v_add_u32 v11, 8192, v10
    v_cmp_ge_u32 vcc, 7, v15
    ds_read_b64_tr_b16 a[24:25], v11 offset:0
    s_nop 0
    v_cndmask_b32 v194, v2, 0, vcc
    ds_read_b64_tr_b16 a[26:27], v11 offset:512
    ds_read_b64_tr_b16 a[28:29], v11 offset:12288
    v_cmp_ge_i32 vcc, -9, v15
    ds_read_b64_tr_b16 a[30:31], v11 offset:12800
    s_nop 0
    v_cndmask_b32 v198, v2, 0, vcc
    ds_read_b64_tr_b16 a[88:89], v11 offset:1024
    ds_read_b64_tr_b16 a[90:91], v11 offset:1536
    s_and_b64 vcc, vcc, s[30:31]
    ds_read_b64_tr_b16 a[92:93], v11 offset:13312
    v_cndmask_b32 v206, v2, 0, vcc
    ds_read_b64_tr_b16 a[94:95], v11 offset:13824
    ds_read_b64_tr_b16 a[152:153], v11 offset:2048
    v_cmp_ge_i32 vcc, -1, v15
    ds_read_b64_tr_b16 a[154:155], v11 offset:2560
    v_cmp_ge_u32 s[26:27], 7, v14
    ds_read_b64_tr_b16 a[156:157], v11 offset:14336
    ds_read_b64_tr_b16 a[158:159], v11 offset:14848
    s_and_b64 vcc, vcc, s[26:27]
    s_waitcnt vmcnt(22)
    s_waitcnt lgkmcnt(0)
    s_barrier
    v_add_u32 v11, 32768, v10
    s_and_b64 vcc, vcc, s[30:31]
    ds_read_b64_tr_b16 a[32:33], v11 offset:0
    ds_read_b64_tr_b16 a[34:35], v11 offset:512
    v_cndmask_b32 v202, v2, 0, vcc
    ds_read_b64_tr_b16 a[36:37], v11 offset:12288
    ds_read_b64_tr_b16 a[38:39], v11 offset:12800
    v_add_u32 v14, 3, v13
    ds_read_b64_tr_b16 a[96:97], v11 offset:1024
    v_sub_u32 v15, v12, v14
    ds_read_b64_tr_b16 a[98:99], v11 offset:1536
    ds_read_b64_tr_b16 a[100:101], v11 offset:13312
    v_cmp_ge_u32 vcc, 7, v15
    ds_read_b64_tr_b16 a[102:103], v11 offset:13824
    s_nop 0
    v_cndmask_b32 v195, v2, 0, vcc
    ds_read_b64_tr_b16 a[160:161], v11 offset:2048
    ds_read_b64_tr_b16 a[162:163], v11 offset:2560
    v_cmp_ge_i32 vcc, -9, v15
    ds_read_b64_tr_b16 a[164:165], v11 offset:14336
    s_nop 0
    v_cndmask_b32 v199, v2, 0, vcc
    ds_read_b64_tr_b16 a[166:167], v11 offset:14848
    s_waitcnt vmcnt(16)
    s_waitcnt lgkmcnt(0)
    s_barrier
    v_add_u32 v11, 57344, v10
    s_and_b64 vcc, vcc, s[30:31]
    ds_read_b64_tr_b16 a[40:41], v11 offset:0
    v_cndmask_b32 v207, v2, 0, vcc
    ds_read_b64_tr_b16 a[42:43], v11 offset:512
    ds_read_b64_tr_b16 a[44:45], v11 offset:12288
    v_cmp_ge_i32 vcc, -1, v15
    ds_read_b64_tr_b16 a[46:47], v11 offset:12800
    v_cmp_ge_u32 s[26:27], 7, v14
    ds_read_b64_tr_b16 a[104:105], v11 offset:1024
    ds_read_b64_tr_b16 a[106:107], v11 offset:1536
    s_and_b64 vcc, vcc, s[26:27]
    ds_read_b64_tr_b16 a[108:109], v11 offset:13312
    ds_read_b64_tr_b16 a[110:111], v11 offset:13824
    s_and_b64 vcc, vcc, s[30:31]
    ds_read_b64_tr_b16 a[168:169], v11 offset:2048
    v_cndmask_b32 v203, v2, 0, vcc
    ds_read_b64_tr_b16 a[170:171], v11 offset:2560
    ds_read_b64_tr_b16 a[172:173], v11 offset:14336
    v_lshrrev_b32 v12, 2, v0
    ds_read_b64_tr_b16 a[174:175], v11 offset:14848
    v_and_b32 v13, 3, v0
    s_waitcnt vmcnt(6)
    s_waitcnt lgkmcnt(0)
    s_barrier
    v_add_u32 v11, 81920, v10
    ds_read_b64_tr_b16 a[48:49], v11 offset:0
    v_and_b32 v14, 1, v12
    ds_read_b64_tr_b16 a[50:51], v11 offset:512
    v_lshl_or_b32 v14, v14, 2, v13
    ds_read_b64_tr_b16 a[52:53], v11 offset:12288
    ds_read_b64_tr_b16 a[54:55], v11 offset:12800
    v_lshlrev_b32 v12, 10, v12
    ds_read_b64_tr_b16 a[112:113], v11 offset:1024
    v_lshl_or_b32 v12, v13, 8, v12
    ds_read_b64_tr_b16 a[114:115], v11 offset:1536
    ds_read_b64_tr_b16 a[116:117], v11 offset:13312
    v_lshl_or_b32 v12, v14, 4, v12
    ds_read_b64_tr_b16 a[118:119], v11 offset:13824
    s_lshl_b32 s32, s3, 6
    ds_read_b64_tr_b16 a[176:177], v11 offset:2048
    ds_read_b64_tr_b16 a[178:179], v11 offset:2560
    v_xor_b32 v228, s32, v12
    ds_read_b64_tr_b16 a[180:181], v11 offset:14336
    ds_read_b64_tr_b16 a[182:183], v11 offset:14848
    v_add_u32 v229, 0x10000, v228
    s_waitcnt vmcnt(0)
    s_waitcnt lgkmcnt(0)
    s_barrier
    v_add_u32 v11, 106496, v10
    v_and_b32 v12, 15, v0
    ds_read_b64_tr_b16 a[56:57], v11 offset:0
    ds_read_b64_tr_b16 a[58:59], v11 offset:512
    v_lshrrev_b32 v15, 4, v0
    ds_read_b64_tr_b16 a[60:61], v11 offset:12288
    v_xor_b32 v12, v12, v15
    ds_read_b64_tr_b16 a[62:63], v11 offset:12800
    ds_read_b64_tr_b16 a[120:121], v11 offset:1024
    v_lshlrev_b32 v12, 4, v12
    ds_read_b64_tr_b16 a[122:123], v11 offset:1536
    v_lshl_or_b32 v224, v15, 8, v12
    ds_read_b64_tr_b16 a[124:125], v11 offset:13312
    ds_read_b64_tr_b16 a[126:127], v11 offset:13824
    v_xor_b32 v225, 64, v224
    ds_read_b64_tr_b16 a[184:185], v11 offset:2048
    v_add_u32 v226, 0x10000, v224
    ds_read_b64_tr_b16 a[186:187], v11 offset:2560
    ds_read_b64_tr_b16 a[188:189], v11 offset:14336
    v_add_u32 v227, 0x10000, v225
    ds_read_b64_tr_b16 a[190:191], v11 offset:14848
    s_waitcnt lgkmcnt(0)
    s_barrier
    v_lshrrev_b32 v7, 4, v186
    v_cmp_eq_u32 s[30:31], s39, v7
    v_cmp_eq_u32 vcc, s96, v177
    s_nop 0
    s_and_b64 vcc, vcc, s[30:31]
    v_cmp_eq_u32 s[28:29], s96, v179
    s_nop 0
    s_and_b64 vcc, vcc, s[28:29]
    v_cmp_eq_u32 s[28:29], s96, v181
    s_nop 0
    s_and_b64 vcc, vcc, s[28:29]
    v_cmp_eq_u32 s[28:29], s96, v183
    s_nop 0
    s_and_b64 vcc, vcc, s[28:29]
    v_cmp_eq_u32 s[28:29], s96, v185
    s_nop 0
    s_and_b64 vcc, vcc, s[28:29]
    s_cmp_eq_u64 vcc, exec
    s_cbranch_scc1 L_modok_4
    s_mov_b32 s101, 0
L_spin_5:
    buffer_load_dwordx4 v[176:179], v4, s[12:15], s36 offen sc1
    buffer_load_dwordx4 v[180:183], v4, s[12:15], s36 offen offset:16 sc1
    buffer_load_dwordx2 v[184:185], v5, s[12:15], s37 offen sc1
    buffer_load_dword v186, v6, s[12:15], s38 offen sc1
    s_waitcnt vmcnt(0)
    v_lshrrev_b32 v7, 4, v186
    v_cmp_eq_u32 s[30:31], s39, v7
    v_cmp_eq_u32 vcc, s96, v177
    s_nop 0
    s_and_b64 vcc, vcc, s[30:31]
    v_cmp_eq_u32 s[28:29], s96, v179
    s_nop 0
    s_and_b64 vcc, vcc, s[28:29]
    v_cmp_eq_u32 s[28:29], s96, v181
    s_nop 0
    s_and_b64 vcc, vcc, s[28:29]
    v_cmp_eq_u32 s[28:29], s96, v183
    s_nop 0
    s_and_b64 vcc, vcc, s[28:29]
    v_cmp_eq_u32 s[28:29], s96, v185
    s_nop 0
    s_and_b64 vcc, vcc, s[28:29]
    s_cmp_eq_u64 vcc, exec
    s_cbranch_scc1 L_spun_6
    s_add_u32 s101, s101, 1
    s_cmp_lt_u32 s101, 1048576
    s_cbranch_scc1 L_spin_5
L_spun_6:
L_modok_4:
    s_getreg_b32 s24, hwreg(HW_REG_XCC_ID, 0, 4)
    v_and_b32 v7, 15, v186
    v_cmp_eq_u32 vcc, s24, v7
    v_mov_b32 v177, v178
    v_mov_b32 v178, v180
    v_mov_b32 v179, v182
    s_cmp_eq_u64 vcc, exec
    s_cselect_b32 s97, 1, 0
    s_lshl_b32 s26, s3, 10
    s_add_u32 s26, s26, 81920
    v_add_u32 v13, s26, v1
    ds_write_b128 v13, v[176:179]
    s_lshl_b32 s26, s3, 8
    s_add_u32 s26, s26, 86016
    v_lshlrev_b32 v12, 2, v0
    v_add_u32 v12, s26, v12
    ds_write_b32 v12, v184
    v_add_u32 v12, 81920, v4
    s_waitcnt lgkmcnt(0)
    s_barrier
    ds_read_b128 v[184:187], v12
    ds_read_b128 v[188:191], v12 offset:16
    ds_read_b128 v[176:179], v12 offset:2048
    ds_read_b128 v[180:183], v12 offset:2064
    s_lshr_b32 s24, s3, 1
    s_lshl_b32 s25, s4, 1
    s_add_u32 s24, s24, s25
    s_lshl_b32 s24, s24, 4
    s_lshl_b32 s25, s5, 1
    s_add_u32 s24, s24, s25
    s_and_b32 s25, s3, 1
    s_add_u32 s24, s24, s25
    s_lshl_b32 s24, s24, 9
    s_add_u32 s24, s24, 524288
    v_and_b32 v2, 3, v0
    v_lshlrev_b32 v2, 7, v2
    buffer_load_dword v252, v2, s[12:15], s24 offen sc1
    s_waitcnt lgkmcnt(1)
    v_pk_fma_f32 v[16:17], v[16:17], v[176:177], v[184:185]
    v_pk_fma_f32 v[18:19], v[18:19], v[178:179], v[186:187]
    s_waitcnt lgkmcnt(0)
    v_pk_fma_f32 v[20:21], v[20:21], v[180:181], v[188:189]
    v_pk_fma_f32 v[22:23], v[22:23], v[182:183], v[190:191]
    v_xor_b32 v2, 0, v229
    v_cvt_pk_bf16_f32 v16, v16, v17
    v_cvt_pk_bf16_f32 v17, v18, v19
    v_cvt_pk_bf16_f32 v18, v20, v21
    v_cvt_pk_bf16_f32 v19, v22, v23
    ds_write_b128 v2, v[16:19] offset:0
    v_pk_fma_f32 v[24:25], v[24:25], v[176:177], v[184:185]
    v_pk_fma_f32 v[26:27], v[26:27], v[178:179], v[186:187]
    v_pk_fma_f32 v[28:29], v[28:29], v[180:181], v[188:189]
    v_pk_fma_f32 v[30:31], v[30:31], v[182:183], v[190:191]
    v_xor_b32 v3, 16, v229
    v_cvt_pk_bf16_f32 v24, v24, v25
    v_cvt_pk_bf16_f32 v25, v26, v27
    v_cvt_pk_bf16_f32 v26, v28, v29
    v_cvt_pk_bf16_f32 v27, v30, v31
    ds_write_b128 v3, v[24:27] offset:0
    v_pk_fma_f32 v[32:33], v[32:33], v[176:177], v[184:185]
    v_pk_fma_f32 v[34:35], v[34:35], v[178:179], v[186:187]
    v_pk_fma_f32 v[36:37], v[36:37], v[180:181], v[188:189]
    v_pk_fma_f32 v[38:39], v[38:39], v[182:183], v[190:191]
    v_xor_b32 v2, 32, v229
    v_cvt_pk_bf16_f32 v32, v32, v33
    v_cvt_pk_bf16_f32 v33, v34, v35
    v_cvt_pk_bf16_f32 v34, v36, v37
    v_cvt_pk_bf16_f32 v35, v38, v39
    ds_write_b128 v2, v[32:35] offset:0
    v_pk_fma_f32 v[40:41], v[40:41], v[176:177], v[184:185]
    v_pk_fma_f32 v[42:43], v[42:43], v[178:179], v[186:187]
    v_pk_fma_f32 v[44:45], v[44:45], v[180:181], v[188:189]
    v_pk_fma_f32 v[46:47], v[46:47], v[182:183], v[190:191]
    v_xor_b32 v3, 48, v229
    v_cvt_pk_bf16_f32 v40, v40, v41
    v_cvt_pk_bf16_f32 v41, v42, v43
    v_cvt_pk_bf16_f32 v42, v44, v45
    v_cvt_pk_bf16_f32 v43, v46, v47
    ds_write_b128 v3, v[40:43] offset:0
    v_pk_fma_f32 v[48:49], v[48:49], v[176:177], v[184:185]
    v_pk_fma_f32 v[50:51], v[50:51], v[178:179], v[186:187]
    v_pk_fma_f32 v[52:53], v[52:53], v[180:181], v[188:189]
    v_pk_fma_f32 v[54:55], v[54:55], v[182:183], v[190:191]
    v_xor_b32 v2, 0, v228
    v_cvt_pk_bf16_f32 v48, v48, v49
    v_cvt_pk_bf16_f32 v49, v50, v51
    v_cvt_pk_bf16_f32 v50, v52, v53
    v_cvt_pk_bf16_f32 v51, v54, v55
    ds_write_b128 v2, v[48:51] offset:0
    v_pk_fma_f32 v[56:57], v[56:57], v[176:177], v[184:185]
    v_pk_fma_f32 v[58:59], v[58:59], v[178:179], v[186:187]
    v_pk_fma_f32 v[60:61], v[60:61], v[180:181], v[188:189]
    v_pk_fma_f32 v[62:63], v[62:63], v[182:183], v[190:191]
    v_xor_b32 v3, 16, v228
    v_cvt_pk_bf16_f32 v56, v56, v57
    v_cvt_pk_bf16_f32 v57, v58, v59
    v_cvt_pk_bf16_f32 v58, v60, v61
    v_cvt_pk_bf16_f32 v59, v62, v63
    ds_write_b128 v3, v[56:59] offset:0
    v_pk_fma_f32 v[64:65], v[64:65], v[176:177], v[184:185]
    v_pk_fma_f32 v[66:67], v[66:67], v[178:179], v[186:187]
    v_pk_fma_f32 v[68:69], v[68:69], v[180:181], v[188:189]
    v_pk_fma_f32 v[70:71], v[70:71], v[182:183], v[190:191]
    v_xor_b32 v2, 32, v228
    v_cvt_pk_bf16_f32 v64, v64, v65
    v_cvt_pk_bf16_f32 v65, v66, v67
    v_cvt_pk_bf16_f32 v66, v68, v69
    v_cvt_pk_bf16_f32 v67, v70, v71
    ds_write_b128 v2, v[64:67] offset:0
    v_pk_fma_f32 v[72:73], v[72:73], v[176:177], v[184:185]
    v_pk_fma_f32 v[74:75], v[74:75], v[178:179], v[186:187]
    v_pk_fma_f32 v[76:77], v[76:77], v[180:181], v[188:189]
    v_pk_fma_f32 v[78:79], v[78:79], v[182:183], v[190:191]
    v_xor_b32 v3, 48, v228
    v_cvt_pk_bf16_f32 v72, v72, v73
    v_cvt_pk_bf16_f32 v73, v74, v75
    v_cvt_pk_bf16_f32 v74, v76, v77
    v_cvt_pk_bf16_f32 v75, v78, v79
    ds_write_b128 v3, v[72:75] offset:0
    s_waitcnt lgkmcnt(0)
    s_barrier
    ds_read_b128 v[208:211], v226 offset:0
    ds_read_b128 v[212:215], v227 offset:1024
    s_waitcnt lgkmcnt(1)
    v_mfma_f32_16x16x32_bf16 v[48:51], a[64:67], v[208:211], 0
    ds_read_b128 v[216:219], v226 offset:2048
    v_fma_f32 v80, v80, v176, v184
    v_fma_f32 v81, v81, v177, v185
    v_fma_f32 v82, v82, v178, v186
    v_fma_f32 v83, v83, v179, v187
    s_mov_b32 s16, s40
    s_mov_b32 s17, s41
    s_mov_b32 s18, 0x80000
    s_mov_b32 s19, 0x20000
    s_mul_i32 s66, s3, 131072
    s_lshl_b32 s67, s5, 7
    s_add_u32 s66, s66, s67
    s_mul_i32 s67, s3, 16384
    s_add_u32 s67, s67, 87040
    v_mfma_f32_16x16x32_bf16 v[68:71], v[208:211], a[128:131], 0
    v_add_u32 v8, s67, v242
    v_add_u32 v9, s67, v243
    s_waitcnt lgkmcnt(1)
    v_mfma_f32_16x16x32_bf16 v[48:51], a[68:71], v[212:215], v[48:51]
    ds_read_b128 v[220:223], v227 offset:3072
    v_fma_f32 v84, v84, v180, v188
    v_fma_f32 v85, v85, v181, v189
    v_mfma_f32_16x16x32_bf16 v[68:71], v[212:215], a[132:135], v[68:71]
    v_fma_f32 v86, v86, v182, v190
    v_fma_f32 v87, v87, v183, v191
    s_waitcnt lgkmcnt(1)
    v_mfma_f32_16x16x32_bf16 v[48:51], a[72:75], v[216:219], v[48:51]
    ds_read_b128 v[208:211], v226 offset:4096
    v_xor_b32 v2, 0, v228
    v_cvt_pk_bf16_f32 v80, v80, v81
    v_cvt_pk_bf16_f32 v81, v82, v83
    v_mfma_f32_16x16x32_bf16 v[68:71], v[216:219], a[136:139], v[68:71]
    v_cvt_pk_bf16_f32 v82, v84, v85
    s_add_u32 s28, s66, 0
    s_add_u32 m0, s67, 0
    s_nop 0
    buffer_load_dwordx4 v241, s[16:19], s28 offen lds
    s_waitcnt lgkmcnt(1)
    v_mfma_f32_16x16x32_bf16 v[48:51], a[76:79], v[220:223], v[48:51]
    ds_read_b128 v[212:215], v227 offset:5120
    v_cvt_pk_bf16_f32 v83, v86, v87
    ds_write_b128 v2, v[80:83] offset:16384
    v_mfma_f32_16x16x32_bf16 v[68:71], v[220:223], a[140:143], v[68:71]
    v_fma_f32 v88, v88, v176, v184
    v_fma_f32 v89, v89, v177, v185
    s_waitcnt lgkmcnt(2)
    v_mfma_f32_16x16x32_bf16 v[48:51], a[80:83], v[208:211], v[48:51]
    ds_read_b128 v[216:219], v226 offset:6144
    v_fma_f32 v90, v90, v178, v186
    v_fma_f32 v91, v91, v179, v187
    v_fma_f32 v92, v92, v180, v188
    v_mfma_f32_16x16x32_bf16 v[68:71], v[208:211], a[144:147], v[68:71]
    v_fma_f32 v93, v93, v181, v189
    s_add_u32 s28, s66, 8192
    s_add_u32 m0, s67, 1024
    s_nop 0
    buffer_load_dwordx4 v241, s[16:19], s28 offen lds
    s_waitcnt lgkmcnt(2)
    v_mfma_f32_16x16x32_bf16 v[48:51], a[84:87], v[212:215], v[48:51]
    ds_read_b128 v[220:223], v227 offset:7168
    v_fma_f32 v94, v94, v182, v190
    v_fma_f32 v95, v95, v183, v191
    v_mfma_f32_16x16x32_bf16 v[68:71], v[212:215], a[148:151], v[68:71]
    v_xor_b32 v3, 16, v228
    v_cvt_pk_bf16_f32 v88, v88, v89
    s_waitcnt lgkmcnt(1)
    v_mfma_f32_16x16x32_bf16 v[48:51], a[88:91], v[216:219], v[48:51]
    ds_read_b128 v[208:211], v226 offset:8192
    v_cvt_pk_bf16_f32 v89, v90, v91
    v_cvt_pk_bf16_f32 v90, v92, v93
    v_cvt_pk_bf16_f32 v91, v94, v95
    v_mfma_f32_16x16x32_bf16 v[68:71], v[216:219], a[152:155], v[68:71]
    ds_write_b128 v3, v[88:91] offset:16384
    s_add_u32 s28, s66, 16384
    s_add_u32 m0, s67, 2048
    s_nop 0
    buffer_load_dwordx4 v241, s[16:19], s28 offen lds
    s_waitcnt lgkmcnt(2)
    v_mfma_f32_16x16x32_bf16 v[48:51], a[92:95], v[220:223], v[48:51]
    ds_read_b128 v[212:215], v227 offset:9216
    v_fma_f32 v96, v96, v176, v184
    v_fma_f32 v97, v97, v177, v185
    v_mfma_f32_16x16x32_bf16 v[68:71], v[220:223], a[156:159], v[68:71]
    v_fma_f32 v98, v98, v178, v186
    v_fma_f32 v99, v99, v179, v187
    s_waitcnt lgkmcnt(2)
    v_mfma_f32_16x16x32_bf16 v[48:51], a[96:99], v[208:211], v[48:51]
    ds_read_b128 v[216:219], v226 offset:10240
    v_fma_f32 v100, v100, v180, v188
    v_fma_f32 v101, v101, v181, v189
    v_fma_f32 v102, v102, v182, v190
    v_mfma_f32_16x16x32_bf16 v[68:71], v[208:211], a[160:163], v[68:71]
    v_fma_f32 v103, v103, v183, v191
    s_add_u32 s28, s66, 24576
    s_add_u32 m0, s67, 3072
    s_nop 0
    buffer_load_dwordx4 v241, s[16:19], s28 offen lds
    s_waitcnt lgkmcnt(1)
    v_mfma_f32_16x16x32_bf16 v[48:51], a[100:103], v[212:215], v[48:51]
    ds_read_b128 v[220:223], v227 offset:11264
    v_xor_b32 v2, 32, v228
    v_cvt_pk_bf16_f32 v96, v96, v97
    v_mfma_f32_16x16x32_bf16 v[68:71], v[212:215], a[164:167], v[68:71]
    v_cvt_pk_bf16_f32 v97, v98, v99
    v_cvt_pk_bf16_f32 v98, v100, v101
    s_waitcnt lgkmcnt(1)
    v_mfma_f32_16x16x32_bf16 v[48:51], a[104:107], v[216:219], v[48:51]
    ds_read_b128 v[208:211], v226 offset:12288
    v_cvt_pk_bf16_f32 v99, v102, v103
    ds_write_b128 v2, v[96:99] offset:16384
    v_fma_f32 v104, v104, v176, v184
    v_mfma_f32_16x16x32_bf16 v[68:71], v[216:219], a[168:171], v[68:71]
    v_fma_f32 v105, v105, v177, v185
    s_add_u32 s28, s66, 32768
    s_add_u32 m0, s67, 4096
    s_nop 0
    buffer_load_dwordx4 v241, s[16:19], s28 offen lds
    s_waitcnt lgkmcnt(2)
    v_mfma_f32_16x16x32_bf16 v[48:51], a[108:111], v[220:223], v[48:51]
    ds_read_b128 v[212:215], v227 offset:13312
    v_fma_f32 v106, v106, v178, v186
    v_fma_f32 v107, v107, v179, v187
    v_mfma_f32_16x16x32_bf16 v[68:71], v[220:223], a[172:175], v[68:71]
    v_fma_f32 v108, v108, v180, v188
    v_fma_f32 v109, v109, v181, v189
    s_waitcnt lgkmcnt(2)
    v_mfma_f32_16x16x32_bf16 v[48:51], a[112:115], v[208:211], v[48:51]
    ds_read_b128 v[216:219], v226 offset:14336
    v_fma_f32 v110, v110, v182, v190
    v_fma_f32 v111, v111, v183, v191
    v_xor_b32 v3, 48, v228
    v_mfma_f32_16x16x32_bf16 v[68:71], v[208:211], a[176:179], v[68:71]
    v_cvt_pk_bf16_f32 v104, v104, v105
    s_add_u32 s28, s66, 40960
    s_add_u32 m0, s67, 5120
    s_nop 0
    buffer_load_dwordx4 v241, s[16:19], s28 offen lds
    s_waitcnt lgkmcnt(1)
    v_mfma_f32_16x16x32_bf16 v[48:51], a[116:119], v[212:215], v[48:51]
    ds_read_b128 v[220:223], v227 offset:15360
    v_cvt_pk_bf16_f32 v105, v106, v107
    v_cvt_pk_bf16_f32 v106, v108, v109
    v_mfma_f32_16x16x32_bf16 v[68:71], v[212:215], a[180:183], v[68:71]
    v_cvt_pk_bf16_f32 v107, v110, v111
    ds_write_b128 v3, v[104:107] offset:16384
    s_waitcnt lgkmcnt(2)
    v_mfma_f32_16x16x32_bf16 v[48:51], a[120:123], v[216:219], v[48:51]
    ds_read_b128 v[208:211], v224 offset:0
    s_add_u32 s28, s66, 49152
    s_add_u32 m0, s67, 6144
    s_nop 0
    buffer_load_dwordx4 v241, s[16:19], s28 offen lds
    v_mfma_f32_16x16x32_bf16 v[68:71], v[216:219], a[184:187], v[68:71]
    s_waitcnt lgkmcnt(2)
    v_mfma_f32_16x16x32_bf16 v[48:51], a[124:127], v[220:223], v[48:51]
    ds_read_b128 v[212:215], v225 offset:1024
    v_mfma_f32_16x16x32_bf16 v[68:71], v[220:223], a[188:191], v[68:71]
    s_waitcnt lgkmcnt(1)
    v_mfma_f32_16x16x32_bf16 v[16:19], a[0:3], v[208:211], 0
    ds_read_b128 v[216:219], v224 offset:2048
    v_fma_f32 v112, v112, v176, v184
    v_fma_f32 v113, v113, v177, v185
    v_mfma_f32_16x16x32_bf16 v[32:35], a[64:67], v[208:211], 0
    v_fma_f32 v114, v114, v178, v186
    v_fma_f32 v115, v115, v179, v187
    s_add_u32 s28, s66, 57344
    s_add_u32 m0, s67, 7168
    s_nop 0
    buffer_load_dwordx4 v241, s[16:19], s28 offen lds
    v_mfma_f32_16x16x32_bf16 v[52:55], v[208:211], a[128:131], 0
    s_waitcnt lgkmcnt(1)
    v_mfma_f32_16x16x32_bf16 v[16:19], a[4:7], v[212:215], v[16:19]
    ds_read_b128 v[220:223], v225 offset:3072
    v_fma_f32 v116, v116, v180, v188
    v_mfma_f32_16x16x32_bf16 v[32:35], a[68:71], v[212:215], v[32:35]
    v_fma_f32 v117, v117, v181, v189
    v_fma_f32 v118, v118, v182, v190
    v_mfma_f32_16x16x32_bf16 v[52:55], v[212:215], a[132:135], v[52:55]
    v_fma_f32 v119, v119, v183, v191
    s_waitcnt lgkmcnt(1)
    v_mfma_f32_16x16x32_bf16 v[16:19], a[8:11], v[216:219], v[16:19]
    ds_read_b128 v[208:211], v224 offset:4096
    v_xor_b32 v2, 0, v228
    v_cvt_pk_bf16_f32 v112, v112, v113
    v_mfma_f32_16x16x32_bf16 v[32:35], a[72:75], v[216:219], v[32:35]
    v_cvt_pk_bf16_f32 v113, v114, v115
    v_cvt_pk_bf16_f32 v114, v116, v117
    s_add_u32 s28, s66, 65536
    s_add_u32 m0, s67, 8192
    s_nop 0
    buffer_load_dwordx4 v241, s[16:19], s28 offen lds
    v_mfma_f32_16x16x32_bf16 v[52:55], v[216:219], a[136:139], v[52:55]
    s_waitcnt lgkmcnt(1)
    v_mfma_f32_16x16x32_bf16 v[16:19], a[12:15], v[220:223], v[16:19]
    ds_read_b128 v[212:215], v225 offset:5120
    v_cvt_pk_bf16_f32 v115, v118, v119
    v_mfma_f32_16x16x32_bf16 v[32:35], a[76:79], v[220:223], v[32:35]
    ds_write_b128 v2, v[112:115] offset:32768
    v_fma_f32 v120, v120, v176, v184
    v_mfma_f32_16x16x32_bf16 v[52:55], v[220:223], a[140:143], v[52:55]
    v_fma_f32 v121, v121, v177, v185
    s_waitcnt lgkmcnt(2)
    v_mfma_f32_16x16x32_bf16 v[16:19], a[16:19], v[208:211], v[16:19]
    ds_read_b128 v[216:219], v224 offset:6144
    v_fma_f32 v122, v122, v178, v186
    v_fma_f32 v123, v123, v179, v187
    v_mfma_f32_16x16x32_bf16 v[32:35], a[80:83], v[208:211], v[32:35]
    v_fma_f32 v124, v124, v180, v188
    v_fma_f32 v125, v125, v181, v189
    s_add_u32 s28, s66, 73728
    s_add_u32 m0, s67, 9216
    s_nop 0
    buffer_load_dwordx4 v241, s[16:19], s28 offen lds
    v_mfma_f32_16x16x32_bf16 v[52:55], v[208:211], a[144:147], v[52:55]
    s_waitcnt lgkmcnt(2)
    v_mfma_f32_16x16x32_bf16 v[16:19], a[20:23], v[212:215], v[16:19]
    ds_read_b128 v[220:223], v225 offset:7168
    v_fma_f32 v126, v126, v182, v190
    v_mfma_f32_16x16x32_bf16 v[32:35], a[84:87], v[212:215], v[32:35]
    v_fma_f32 v127, v127, v183, v191
    v_xor_b32 v3, 16, v228
    v_mfma_f32_16x16x32_bf16 v[52:55], v[212:215], a[148:151], v[52:55]
    v_cvt_pk_bf16_f32 v120, v120, v121
    s_waitcnt lgkmcnt(1)
    v_mfma_f32_16x16x32_bf16 v[16:19], a[24:27], v[216:219], v[16:19]
    ds_read_b128 v[208:211], v224 offset:8192
    v_cvt_pk_bf16_f32 v121, v122, v123
    v_cvt_pk_bf16_f32 v122, v124, v125
    v_mfma_f32_16x16x32_bf16 v[32:35], a[88:91], v[216:219], v[32:35]
    v_cvt_pk_bf16_f32 v123, v126, v127
    ds_write_b128 v3, v[120:123] offset:32768
    s_add_u32 s28, s66, 81920
    s_add_u32 m0, s67, 10240
    s_nop 0
    buffer_load_dwordx4 v241, s[16:19], s28 offen lds
    v_mfma_f32_16x16x32_bf16 v[52:55], v[216:219], a[152:155], v[52:55]
    s_waitcnt lgkmcnt(2)
    v_mfma_f32_16x16x32_bf16 v[16:19], a[28:31], v[220:223], v[16:19]
    ds_read_b128 v[212:215], v225 offset:9216
    v_fma_f32 v128, v128, v176, v184
    v_mfma_f32_16x16x32_bf16 v[32:35], a[92:95], v[220:223], v[32:35]
    v_fma_f32 v129, v129, v177, v185
    v_fma_f32 v130, v130, v178, v186
    v_mfma_f32_16x16x32_bf16 v[52:55], v[220:223], a[156:159], v[52:55]
    v_fma_f32 v131, v131, v179, v187
    s_waitcnt lgkmcnt(2)
    v_mfma_f32_16x16x32_bf16 v[16:19], a[32:35], v[208:211], v[16:19]
    ds_read_b128 v[216:219], v224 offset:10240
    s_barrier
    v_fma_f32 v132, v132, v180, v188
    v_mfma_f32_16x16x32_bf16 v[32:35], a[96:99], v[208:211], v[32:35]
    v_fma_f32 v133, v133, v181, v189
    v_fma_f32 v134, v134, v182, v190
    v_fma_f32 v135, v135, v183, v191
    v_mfma_f32_16x16x32_bf16 v[52:55], v[208:211], a[160:163], v[52:55]
    s_add_u32 s28, s66, 90112
    s_add_u32 m0, s67, 11264
    s_nop 0
    buffer_load_dwordx4 v241, s[16:19], s28 offen lds
    s_waitcnt lgkmcnt(1)
    v_mfma_f32_16x16x32_bf16 v[16:19], a[36:39], v[212:215], v[16:19]
    ds_read_b128 v[220:223], v225 offset:11264
    v_xor_b32 v2, 32, v228
    v_mfma_f32_16x16x32_bf16 v[32:35], a[100:103], v[212:215], v[32:35]
    v_cvt_pk_bf16_f32 v128, v128, v129
    v_cvt_pk_bf16_f32 v129, v130, v131
    v_mfma_f32_16x16x32_bf16 v[52:55], v[212:215], a[164:167], v[52:55]
    v_cvt_pk_bf16_f32 v130, v132, v133
    s_waitcnt lgkmcnt(1)
    v_mfma_f32_16x16x32_bf16 v[16:19], a[40:43], v[216:219], v[16:19]
    ds_read_b128 v[208:211], v224 offset:12288
    v_cvt_pk_bf16_f32 v131, v134, v135
    ds_write_b128 v2, v[128:131] offset:32768
    v_mfma_f32_16x16x32_bf16 v[32:35], a[104:107], v[216:219], v[32:35]
    v_fma_f32 v136, v136, v176, v184
    v_fma_f32 v137, v137, v177, v185
    s_add_u32 s28, s66, 98304
    s_add_u32 m0, s67, 12288
    s_nop 0
    buffer_load_dwordx4 v241, s[16:19], s28 offen lds
    v_mfma_f32_16x16x32_bf16 v[52:55], v[216:219], a[168:171], v[52:55]
    s_waitcnt lgkmcnt(2)
    v_mfma_f32_16x16x32_bf16 v[16:19], a[44:47], v[220:223], v[16:19]
    ds_read_b128 v[212:215], v225 offset:13312
    v_fma_f32 v138, v138, v178, v186
    v_mfma_f32_16x16x32_bf16 v[32:35], a[108:111], v[220:223], v[32:35]
    v_fma_f32 v139, v139, v179, v187
    v_fma_f32 v140, v140, v180, v188
    v_mfma_f32_16x16x32_bf16 v[52:55], v[220:223], a[172:175], v[52:55]
    v_fma_f32 v141, v141, v181, v189
    s_waitcnt lgkmcnt(2)
    v_mfma_f32_16x16x32_bf16 v[16:19], a[48:51], v[208:211], v[16:19]
    ds_read_b128 v[216:219], v224 offset:14336
    v_fma_f32 v142, v142, v182, v190
    v_fma_f32 v143, v143, v183, v191
    v_mfma_f32_16x16x32_bf16 v[32:35], a[112:115], v[208:211], v[32:35]
    v_xor_b32 v3, 48, v228
    v_cvt_pk_bf16_f32 v136, v136, v137
    s_add_u32 s28, s66, 106496
    s_add_u32 m0, s67, 13312
    s_nop 0
    buffer_load_dwordx4 v241, s[16:19], s28 offen lds
    v_mfma_f32_16x16x32_bf16 v[52:55], v[208:211], a[176:179], v[52:55]
    s_waitcnt lgkmcnt(1)
    v_mfma_f32_16x16x32_bf16 v[16:19], a[52:55], v[212:215], v[16:19]
    ds_read_b128 v[220:223], v225 offset:15360
    v_cvt_pk_bf16_f32 v137, v138, v139
    v_mfma_f32_16x16x32_bf16 v[32:35], a[116:119], v[212:215], v[32:35]
    v_cvt_pk_bf16_f32 v138, v140, v141
    v_cvt_pk_bf16_f32 v139, v142, v143
    v_mfma_f32_16x16x32_bf16 v[52:55], v[212:215], a[180:183], v[52:55]
    ds_write_b128 v3, v[136:139] offset:32768
    s_waitcnt lgkmcnt(2)
    v_mfma_f32_16x16x32_bf16 v[16:19], a[56:59], v[216:219], v[16:19]
    ds_read_b128 v[208:211], v224 offset:16384
    s_add_u32 s28, s66, 114688
    s_add_u32 m0, s67, 14336
    s_nop 0
    buffer_load_dwordx4 v241, s[16:19], s28 offen lds
    v_mfma_f32_16x16x32_bf16 v[32:35], a[120:123], v[216:219], v[32:35]
    v_mfma_f32_16x16x32_bf16 v[52:55], v[216:219], a[184:187], v[52:55]
    s_waitcnt lgkmcnt(2)
    v_mfma_f32_16x16x32_bf16 v[16:19], a[60:63], v[220:223], v[16:19]
    ds_read_b128 v[212:215], v225 offset:17408
    v_mfma_f32_16x16x32_bf16 v[32:35], a[124:127], v[220:223], v[32:35]
    v_mfma_f32_16x16x32_bf16 v[52:55], v[220:223], a[188:191], v[52:55]
    s_waitcnt lgkmcnt(1)
    v_mfma_f32_16x16x32_bf16 v[20:23], a[0:3], v[208:211], 0
    ds_read_b128 v[216:219], v224 offset:18432
    v_fma_f32 v144, v144, v176, v184
    v_fma_f32 v145, v145, v177, v185
    v_mfma_f32_16x16x32_bf16 v[36:39], a[64:67], v[208:211], 0
    v_fma_f32 v146, v146, v178, v186
    v_fma_f32 v147, v147, v179, v187
    s_add_u32 s28, s66, 122880
    s_add_u32 m0, s67, 15360
    s_nop 0
    buffer_load_dwordx4 v241, s[16:19], s28 offen lds
    v_mfma_f32_16x16x32_bf16 v[56:59], v[208:211], a[128:131], 0
    s_waitcnt lgkmcnt(1)
    v_mfma_f32_16x16x32_bf16 v[20:23], a[4:7], v[212:215], v[20:23]
    ds_read_b128 v[220:223], v225 offset:19456
    v_fma_f32 v148, v148, v180, v188
    v_fma_f32 v149, v149, v181, v189
    v_fma_f32 v150, v150, v182, v190
    v_fma_f32 v151, v151, v183, v191
    s_cmp_eq_u32 s3, 1
    s_cselect_b32 s24, s46, s44
    s_cselect_b32 s25, s47, s45
    s_cmp_eq_u32 s3, 2
    s_cselect_b32 s16, s48, s24
    s_cselect_b32 s17, s49, s25
    s_mov_b32 s18, 1835008
    s_mov_b32 s19, 0x20000
    s_mul_i32 s24, s2, 7168
    s_cmp_eq_u32 s3, 3
    s_cselect_b32 s24, 0x40000000, s24
    v_min_u32 v7, 55, v0
    v_lshlrev_b32 v7, 7, v7
    buffer_load_dword v252, v7, s[16:19], s24 offen
    s_mov_b32 s16, s40
    s_mov_b32 s17, s41
    s_mov_b32 s18, 0x80000
    s_mov_b32 s19, 0x20000
    v_mfma_f32_16x16x32_bf16 v[36:39], a[68:71], v[212:215], v[36:39]
    v_mfma_f32_16x16x32_bf16 v[56:59], v[212:215], a[132:135], v[56:59]
    s_waitcnt lgkmcnt(1)
    v_mfma_f32_16x16x32_bf16 v[20:23], a[8:11], v[216:219], v[20:23]
    ds_read_b128 v[208:211], v224 offset:20480
    v_xor_b32 v2, 0, v228
    v_mfma_f32_16x16x32_bf16 v[36:39], a[72:75], v[216:219], v[36:39]
    v_cvt_pk_bf16_f32 v144, v144, v145
    v_cvt_pk_bf16_f32 v145, v146, v147
    v_mfma_f32_16x16x32_bf16 v[56:59], v[216:219], a[136:139], v[56:59]
    v_cvt_pk_bf16_f32 v146, v148, v149
    s_waitcnt lgkmcnt(1)
    v_mfma_f32_16x16x32_bf16 v[20:23], a[12:15], v[220:223], v[20:23]
    ds_read_b128 v[212:215], v225 offset:21504
    v_cvt_pk_bf16_f32 v147, v150, v151
    v_mfma_f32_16x16x32_bf16 v[36:39], a[76:79], v[220:223], v[36:39]
    ds_write_b128 v2, v[144:147] offset:49152
    v_fma_f32 v152, v152, v176, v184
    v_mfma_f32_16x16x32_bf16 v[56:59], v[220:223], a[140:143], v[56:59]
    v_fma_f32 v153, v153, v177, v185
    s_waitcnt lgkmcnt(2)
    v_mfma_f32_16x16x32_bf16 v[20:23], a[16:19], v[208:211], v[20:23]
    ds_read_b128 v[216:219], v224 offset:22528
    v_fma_f32 v154, v154, v178, v186
    v_mfma_f32_16x16x32_bf16 v[36:39], a[80:83], v[208:211], v[36:39]
    v_fma_f32 v155, v155, v179, v187
    v_fma_f32 v156, v156, v180, v188
    v_mfma_f32_16x16x32_bf16 v[56:59], v[208:211], a[144:147], v[56:59]
    v_fma_f32 v157, v157, v181, v189
    s_waitcnt lgkmcnt(2)
    v_mfma_f32_16x16x32_bf16 v[20:23], a[20:23], v[212:215], v[20:23]
    ds_read_b128 v[220:223], v225 offset:23552
    v_fma_f32 v158, v158, v182, v190
    v_mfma_f32_16x16x32_bf16 v[36:39], a[84:87], v[212:215], v[36:39]
    v_fma_f32 v159, v159, v183, v191
    v_xor_b32 v3, 16, v228
    v_mfma_f32_16x16x32_bf16 v[56:59], v[212:215], a[148:151], v[56:59]
    v_cvt_pk_bf16_f32 v152, v152, v153
    s_waitcnt lgkmcnt(1)
    v_mfma_f32_16x16x32_bf16 v[20:23], a[24:27], v[216:219], v[20:23]
    ds_read_b128 v[208:211], v224 offset:24576
    v_cvt_pk_bf16_f32 v153, v154, v155
    v_mfma_f32_16x16x32_bf16 v[36:39], a[88:91], v[216:219], v[36:39]
    v_cvt_pk_bf16_f32 v154, v156, v157
    v_cvt_pk_bf16_f32 v155, v158, v159
    v_mfma_f32_16x16x32_bf16 v[56:59], v[216:219], a[152:155], v[56:59]
    ds_write_b128 v3, v[152:155] offset:49152
    s_waitcnt lgkmcnt(2)
    v_mfma_f32_16x16x32_bf16 v[20:23], a[28:31], v[220:223], v[20:23]
    ds_read_b128 v[212:215], v225 offset:25600
    v_fma_f32 v160, v160, v176, v184
    v_mfma_f32_16x16x32_bf16 v[36:39], a[92:95], v[220:223], v[36:39]
    v_fma_f32 v161, v161, v177, v185
    v_fma_f32 v162, v162, v178, v186
    v_mfma_f32_16x16x32_bf16 v[56:59], v[220:223], a[156:159], v[56:59]
    v_fma_f32 v163, v163, v179, v187
    s_waitcnt lgkmcnt(2)
    v_mfma_f32_16x16x32_bf16 v[20:23], a[32:35], v[208:211], v[20:23]
    ds_read_b128 v[216:219], v224 offset:26624
    s_barrier
    v_mfma_f32_16x16x32_bf16 v[36:39], a[96:99], v[208:211], v[36:39]
    v_fma_f32 v164, v164, v180, v188
    v_fma_f32 v165, v165, v181, v189
    v_mfma_f32_16x16x32_bf16 v[56:59], v[208:211], a[160:163], v[56:59]
    v_fma_f32 v166, v166, v182, v190
    v_fma_f32 v167, v167, v183, v191
    s_waitcnt lgkmcnt(1)
    v_mfma_f32_16x16x32_bf16 v[20:23], a[36:39], v[212:215], v[20:23]
    ds_read_b128 v[220:223], v225 offset:27648
    v_xor_b32 v2, 32, v228
    v_mfma_f32_16x16x32_bf16 v[36:39], a[100:103], v[212:215], v[36:39]
    v_cvt_pk_bf16_f32 v160, v160, v161
    v_cvt_pk_bf16_f32 v161, v162, v163
    v_mfma_f32_16x16x32_bf16 v[56:59], v[212:215], a[164:167], v[56:59]
    v_cvt_pk_bf16_f32 v162, v164, v165
    s_waitcnt lgkmcnt(1)
    v_mfma_f32_16x16x32_bf16 v[20:23], a[40:43], v[216:219], v[20:23]
    ds_read_b128 v[208:211], v224 offset:28672
    v_cvt_pk_bf16_f32 v163, v166, v167
    v_mfma_f32_16x16x32_bf16 v[36:39], a[104:107], v[216:219], v[36:39]
    ds_write_b128 v2, v[160:163] offset:49152
    v_fma_f32 v168, v168, v176, v184
    v_mfma_f32_16x16x32_bf16 v[56:59], v[216:219], a[168:171], v[56:59]
    v_fma_f32 v169, v169, v177, v185
    s_waitcnt lgkmcnt(2)
    v_mfma_f32_16x16x32_bf16 v[20:23], a[44:47], v[220:223], v[20:23]
    ds_read_b128 v[212:215], v225 offset:29696
    v_fma_f32 v170, v170, v178, v186
    v_mfma_f32_16x16x32_bf16 v[36:39], a[108:111], v[220:223], v[36:39]
    v_fma_f32 v171, v171, v179, v187
    v_fma_f32 v172, v172, v180, v188
    v_mfma_f32_16x16x32_bf16 v[56:59], v[220:223], a[172:175], v[56:59]
    v_fma_f32 v173, v173, v181, v189
    s_waitcnt lgkmcnt(2)
    v_mfma_f32_16x16x32_bf16 v[20:23], a[48:51], v[208:211], v[20:23]
    ds_read_b128 v[216:219], v224 offset:30720
    v_fma_f32 v174, v174, v182, v190
    v_mfma_f32_16x16x32_bf16 v[36:39], a[112:115], v[208:211], v[36:39]
    v_fma_f32 v175, v175, v183, v191
    v_xor_b32 v3, 48, v228
    v_mfma_f32_16x16x32_bf16 v[56:59], v[208:211], a[176:179], v[56:59]
    v_cvt_pk_bf16_f32 v168, v168, v169
    s_waitcnt lgkmcnt(1)
    v_mfma_f32_16x16x32_bf16 v[20:23], a[52:55], v[212:215], v[20:23]
    ds_read_b128 v[220:223], v225 offset:31744
    v_cvt_pk_bf16_f32 v169, v170, v171
    v_mfma_f32_16x16x32_bf16 v[36:39], a[116:119], v[212:215], v[36:39]
    v_cvt_pk_bf16_f32 v170, v172, v173
    v_cvt_pk_bf16_f32 v171, v174, v175
    v_mfma_f32_16x16x32_bf16 v[56:59], v[212:215], a[180:183], v[56:59]
    ds_write_b128 v3, v[168:171] offset:49152
    s_waitcnt lgkmcnt(2)
    v_mfma_f32_16x16x32_bf16 v[20:23], a[56:59], v[216:219], v[20:23]
    ds_read_b128 v[208:211], v224 offset:32768
    v_mfma_f32_16x16x32_bf16 v[36:39], a[120:123], v[216:219], v[36:39]
    v_mfma_f32_16x16x32_bf16 v[56:59], v[216:219], a[184:187], v[56:59]
    s_waitcnt lgkmcnt(2)
    v_mfma_f32_16x16x32_bf16 v[20:23], a[60:63], v[220:223], v[20:23]
    ds_read_b128 v[212:215], v225 offset:33792
    v_mfma_f32_16x16x32_bf16 v[36:39], a[124:127], v[220:223], v[36:39]
    v_mfma_f32_16x16x32_bf16 v[56:59], v[220:223], a[188:191], v[56:59]
    s_waitcnt lgkmcnt(1)
    v_mfma_f32_16x16x32_bf16 v[24:27], a[0:3], v[208:211], 0
    ds_read_b128 v[216:219], v224 offset:34816
    v_mfma_f32_16x16x32_bf16 v[40:43], a[64:67], v[208:211], 0
    v_mfma_f32_16x16x32_bf16 v[60:63], v[208:211], a[128:131], 0
    s_waitcnt lgkmcnt(1)
    v_mfma_f32_16x16x32_bf16 v[24:27], a[4:7], v[212:215], v[24:27]
    ds_read_b128 v[220:223], v225 offset:35840
    v_mfma_f32_16x16x32_bf16 v[40:43], a[68:71], v[212:215], v[40:43]
    v_mfma_f32_16x16x32_bf16 v[60:63], v[212:215], a[132:135], v[60:63]
    s_waitcnt lgkmcnt(1)
    v_mfma_f32_16x16x32_bf16 v[24:27], a[8:11], v[216:219], v[24:27]
    ds_read_b128 v[208:211], v224 offset:36864
    s_waitcnt vmcnt(1)
    v_mfma_f32_16x16x32_bf16 v[40:43], a[72:75], v[216:219], v[40:43]
    ds_read_b64_tr_b16 a[192:193], v8 offset:0
    ds_read_b64_tr_b16 a[194:195], v8 offset:1024
    v_mfma_f32_16x16x32_bf16 v[60:63], v[216:219], a[136:139], v[60:63]
    ds_read_b64_tr_b16 a[196:197], v9 offset:0
    ds_read_b64_tr_b16 a[198:199], v9 offset:1024
    s_waitcnt lgkmcnt(5)
    v_mfma_f32_16x16x32_bf16 v[24:27], a[12:15], v[220:223], v[24:27]
    ds_read_b128 v[212:215], v225 offset:37888
    ds_read_b64_tr_b16 a[200:201], v8 offset:2048
    v_mfma_f32_16x16x32_bf16 v[40:43], a[76:79], v[220:223], v[40:43]
    ds_read_b64_tr_b16 a[202:203], v8 offset:3072
    ds_read_b64_tr_b16 a[204:205], v9 offset:2048
    v_mfma_f32_16x16x32_bf16 v[60:63], v[220:223], a[140:143], v[60:63]
    ds_read_b64_tr_b16 a[206:207], v9 offset:3072
    s_waitcnt lgkmcnt(9)
    v_mfma_f32_16x16x32_bf16 v[24:27], a[16:19], v[208:211], v[24:27]
    ds_read_b128 v[216:219], v224 offset:38912
    ds_read_b64_tr_b16 a[208:209], v8 offset:4096
    v_mfma_f32_16x16x32_bf16 v[40:43], a[80:83], v[208:211], v[40:43]
    ds_read_b64_tr_b16 a[210:211], v8 offset:5120
    ds_read_b64_tr_b16 a[212:213], v9 offset:4096
    v_mfma_f32_16x16x32_bf16 v[60:63], v[208:211], a[144:147], v[60:63]
    ds_read_b64_tr_b16 a[214:215], v9 offset:5120
    s_waitcnt lgkmcnt(9)
    v_mfma_f32_16x16x32_bf16 v[24:27], a[20:23], v[212:215], v[24:27]
    ds_read_b128 v[220:223], v225 offset:39936
    ds_read_b64_tr_b16 a[216:217], v8 offset:6144
    v_mfma_f32_16x16x32_bf16 v[40:43], a[84:87], v[212:215], v[40:43]
    ds_read_b64_tr_b16 a[218:219], v8 offset:7168
    ds_read_b64_tr_b16 a[220:221], v9 offset:6144
    v_mfma_f32_16x16x32_bf16 v[60:63], v[212:215], a[148:151], v[60:63]
    ds_read_b64_tr_b16 a[222:223], v9 offset:7168
    s_waitcnt lgkmcnt(9)
    v_mfma_f32_16x16x32_bf16 v[24:27], a[24:27], v[216:219], v[24:27]
    ds_read_b128 v[208:211], v224 offset:40960
    ds_read_b64_tr_b16 a[224:225], v8 offset:8192
    v_mfma_f32_16x16x32_bf16 v[40:43], a[88:91], v[216:219], v[40:43]
    ds_read_b64_tr_b16 a[226:227], v8 offset:9216
    ds_read_b64_tr_b16 a[228:229], v9 offset:8192
    v_mfma_f32_16x16x32_bf16 v[60:63], v[216:219], a[152:155], v[60:63]
    ds_read_b64_tr_b16 a[230:231], v9 offset:9216
    s_waitcnt lgkmcnt(9)
    v_mfma_f32_16x16x32_bf16 v[24:27], a[28:31], v[220:223], v[24:27]
    ds_read_b128 v[212:215], v225 offset:41984
    ds_read_b64_tr_b16 a[232:233], v8 offset:10240
    v_mfma_f32_16x16x32_bf16 v[40:43], a[92:95], v[220:223], v[40:43]
    ds_read_b64_tr_b16 a[234:235], v8 offset:11264
    ds_read_b64_tr_b16 a[236:237], v9 offset:10240
    v_mfma_f32_16x16x32_bf16 v[60:63], v[220:223], a[156:159], v[60:63]
    ds_read_b64_tr_b16 a[238:239], v9 offset:11264
    s_waitcnt lgkmcnt(9)
    v_mfma_f32_16x16x32_bf16 v[24:27], a[32:35], v[208:211], v[24:27]
    ds_read_b128 v[216:219], v224 offset:43008
    s_barrier
    v_mfma_f32_16x16x32_bf16 v[40:43], a[96:99], v[208:211], v[40:43]
    ds_read_b64_tr_b16 a[240:241], v8 offset:12288
    ds_read_b64_tr_b16 a[242:243], v8 offset:13312
    v_mfma_f32_16x16x32_bf16 v[60:63], v[208:211], a[160:163], v[60:63]
    ds_read_b64_tr_b16 a[244:245], v9 offset:12288
    ds_read_b64_tr_b16 a[246:247], v9 offset:13312
    s_waitcnt lgkmcnt(9)
    v_mfma_f32_16x16x32_bf16 v[24:27], a[36:39], v[212:215], v[24:27]
    ds_read_b128 v[220:223], v225 offset:44032
    ds_read_b64_tr_b16 a[248:249], v8 offset:14336
    v_mfma_f32_16x16x32_bf16 v[40:43], a[100:103], v[212:215], v[40:43]
    ds_read_b64_tr_b16 a[250:251], v8 offset:15360
    ds_read_b64_tr_b16 a[252:253], v9 offset:14336
    v_mfma_f32_16x16x32_bf16 v[60:63], v[212:215], a[164:167], v[60:63]
    ds_read_b64_tr_b16 a[254:255], v9 offset:15360
    s_waitcnt lgkmcnt(9)
    v_mfma_f32_16x16x32_bf16 v[24:27], a[40:43], v[216:219], v[24:27]
    ds_read_b128 v[208:211], v224 offset:45056
    v_mfma_f32_16x16x32_bf16 v[40:43], a[104:107], v[216:219], v[40:43]
    v_mfma_f32_16x16x32_bf16 v[60:63], v[216:219], a[168:171], v[60:63]
    s_waitcnt lgkmcnt(5)
    v_mfma_f32_16x16x32_bf16 v[24:27], a[44:47], v[220:223], v[24:27]
    ds_read_b128 v[212:215], v225 offset:46080
    v_mfma_f32_16x16x32_bf16 v[40:43], a[108:111], v[220:223], v[40:43]
    v_mfma_f32_16x16x32_bf16 v[60:63], v[220:223], a[172:175], v[60:63]
    s_waitcnt lgkmcnt(1)
    v_mfma_f32_16x16x32_bf16 v[24:27], a[48:51], v[208:211], v[24:27]
    ds_read_b128 v[216:219], v224 offset:47104
    v_mfma_f32_16x16x32_bf16 v[40:43], a[112:115], v[208:211], v[40:43]
    v_mfma_f32_16x16x32_bf16 v[60:63], v[208:211], a[176:179], v[60:63]
    s_waitcnt lgkmcnt(1)
    v_mfma_f32_16x16x32_bf16 v[24:27], a[52:55], v[212:215], v[24:27]
    ds_read_b128 v[220:223], v225 offset:48128
    v_mfma_f32_16x16x32_bf16 v[40:43], a[116:119], v[212:215], v[40:43]
    v_mfma_f32_16x16x32_bf16 v[60:63], v[212:215], a[180:183], v[60:63]
    s_waitcnt lgkmcnt(1)
    v_mfma_f32_16x16x32_bf16 v[24:27], a[56:59], v[216:219], v[24:27]
    ds_read_b128 v[208:211], v224 offset:49152
    v_mfma_f32_16x16x32_bf16 v[40:43], a[120:123], v[216:219], v[40:43]
    s_waitcnt lgkmcnt(0)
    s_barrier
    v_mfma_f32_16x16x32_bf16 v[60:63], v[216:219], a[184:187], v[60:63]
    v_mfma_f32_16x16x32_bf16 v[24:27], a[60:63], v[220:223], v[24:27]
    ds_read_b128 v[212:215], v225 offset:50176
    v_mfma_f32_16x16x32_bf16 v[40:43], a[124:127], v[220:223], v[40:43]
    s_add_u32 s63, s60, 0
    v_mfma_f32_16x16x32_bf16 v[60:63], v[220:223], a[188:191], v[60:63]
    s_add_u32 m0, s61, 106496
    v_mfma_f32_16x16x32_bf16 v[28:31], a[0:3], v[208:211], 0
    ds_read_b128 v[216:219], v224 offset:51200
    v_mfma_f32_16x16x32_bf16 v[44:47], a[64:67], v[208:211], 0
    buffer_load_dwordx4 v232, s[20:23], s63 offen lds
    v_mfma_f32_16x16x32_bf16 v[64:67], v[208:211], a[128:131], 0
    s_add_u32 m0, s61, 107520
    s_waitcnt lgkmcnt(1)
    v_mfma_f32_16x16x32_bf16 v[28:31], a[4:7], v[212:215], v[28:31]
    ds_read_b128 v[220:223], v225 offset:52224
    v_mfma_f32_16x16x32_bf16 v[44:47], a[68:71], v[212:215], v[44:47]
    buffer_load_dwordx4 v233, s[20:23], s63 offen lds
    v_mfma_f32_16x16x32_bf16 v[64:67], v[212:215], a[132:135], v[64:67]
    s_add_u32 m0, s61, 108544
    s_waitcnt lgkmcnt(1)
    v_mfma_f32_16x16x32_bf16 v[28:31], a[8:11], v[216:219], v[28:31]
    ds_read_b128 v[208:211], v224 offset:53248
    v_mfma_f32_16x16x32_bf16 v[44:47], a[72:75], v[216:219], v[44:47]
    buffer_load_dwordx4 v234, s[20:23], s63 offen lds
    v_mfma_f32_16x16x32_bf16 v[64:67], v[216:219], a[136:139], v[64:67]
    s_add_u32 m0, s61, 109568
    s_waitcnt lgkmcnt(1)
    v_mfma_f32_16x16x32_bf16 v[28:31], a[12:15], v[220:223], v[28:31]
    ds_read_b128 v[212:215], v225 offset:54272
    v_mfma_f32_16x16x32_bf16 v[44:47], a[76:79], v[220:223], v[44:47]
    buffer_load_dwordx4 v235, s[20:23], s63 offen lds
    v_mfma_f32_16x16x32_bf16 v[64:67], v[220:223], a[140:143], v[64:67]
    s_add_u32 m0, s61, 110592
    s_waitcnt lgkmcnt(1)
    v_mfma_f32_16x16x32_bf16 v[28:31], a[16:19], v[208:211], v[28:31]
    ds_read_b128 v[216:219], v224 offset:55296
    v_mfma_f32_16x16x32_bf16 v[44:47], a[80:83], v[208:211], v[44:47]
    buffer_load_dwordx4 v236, s[20:23], s63 offen lds
    v_mfma_f32_16x16x32_bf16 v[64:67], v[208:211], a[144:147], v[64:67]
    s_add_u32 m0, s61, 111616
    s_waitcnt lgkmcnt(1)
    v_mfma_f32_16x16x32_bf16 v[28:31], a[20:23], v[212:215], v[28:31]
    ds_read_b128 v[220:223], v225 offset:56320
    v_mfma_f32_16x16x32_bf16 v[44:47], a[84:87], v[212:215], v[44:47]
    buffer_load_dwordx4 v237, s[20:23], s63 offen lds
    v_mfma_f32_16x16x32_bf16 v[64:67], v[212:215], a[148:151], v[64:67]
    s_add_u32 m0, s61, 112640
    s_waitcnt lgkmcnt(1)
    v_mfma_f32_16x16x32_bf16 v[28:31], a[24:27], v[216:219], v[28:31]
    ds_read_b128 v[208:211], v224 offset:57344
    v_mfma_f32_16x16x32_bf16 v[44:47], a[88:91], v[216:219], v[44:47]
    buffer_load_dwordx4 v238, s[20:23], s63 offen lds
    v_mfma_f32_16x16x32_bf16 v[64:67], v[216:219], a[152:155], v[64:67]
    s_add_u32 s63, s60, 229376
    s_waitcnt lgkmcnt(1)
    v_mfma_f32_16x16x32_bf16 v[28:31], a[28:31], v[220:223], v[28:31]
    ds_read_b128 v[212:215], v225 offset:58368
    v_mfma_f32_16x16x32_bf16 v[44:47], a[92:95], v[220:223], v[44:47]
    s_add_u32 m0, s61, 135168
    v_mfma_f32_16x16x32_bf16 v[64:67], v[220:223], a[156:159], v[64:67]
    buffer_load_dwordx4 v232, s[20:23], s63 offen lds
    s_waitcnt lgkmcnt(1)
    v_mfma_f32_16x16x32_bf16 v[28:31], a[32:35], v[208:211], v[28:31]
    ds_read_b128 v[216:219], v224 offset:59392
    v_mfma_f32_16x16x32_bf16 v[44:47], a[96:99], v[208:211], v[44:47]
    s_add_u32 m0, s61, 136192
    v_mfma_f32_16x16x32_bf16 v[64:67], v[208:211], a[160:163], v[64:67]
    buffer_load_dwordx4 v233, s[20:23], s63 offen lds
    s_waitcnt lgkmcnt(1)
    v_mfma_f32_16x16x32_bf16 v[28:31], a[36:39], v[212:215], v[28:31]
    ds_read_b128 v[220:223], v225 offset:60416
    v_mfma_f32_16x16x32_bf16 v[44:47], a[100:103], v[212:215], v[44:47]
    s_add_u32 m0, s61, 137216
    v_mfma_f32_16x16x32_bf16 v[64:67], v[212:215], a[164:167], v[64:67]
    buffer_load_dwordx4 v234, s[20:23], s63 offen lds
    s_waitcnt lgkmcnt(1)
    v_mfma_f32_16x16x32_bf16 v[28:31], a[40:43], v[216:219], v[28:31]
    ds_read_b128 v[208:211], v224 offset:61440
    v_mfma_f32_16x16x32_bf16 v[44:47], a[104:107], v[216:219], v[44:47]
    s_add_u32 m0, s61, 138240
    v_mfma_f32_16x16x32_bf16 v[64:67], v[216:219], a[168:171], v[64:67]
    buffer_load_dwordx4 v235, s[20:23], s63 offen lds
    s_waitcnt lgkmcnt(1)
    v_mfma_f32_16x16x32_bf16 v[28:31], a[44:47], v[220:223], v[28:31]
    ds_read_b128 v[212:215], v225 offset:62464
    v_mfma_f32_16x16x32_bf16 v[44:47], a[108:111], v[220:223], v[44:47]
    s_add_u32 m0, s61, 139264
    v_mfma_f32_16x16x32_bf16 v[64:67], v[220:223], a[172:175], v[64:67]
    buffer_load_dwordx4 v236, s[20:23], s63 offen lds
    s_waitcnt lgkmcnt(1)
    v_mfma_f32_16x16x32_bf16 v[28:31], a[48:51], v[208:211], v[28:31]
    ds_read_b128 v[216:219], v224 offset:63488
    v_mfma_f32_16x16x32_bf16 v[44:47], a[112:115], v[208:211], v[44:47]
    s_add_u32 m0, s61, 140288
    v_mfma_f32_16x16x32_bf16 v[64:67], v[208:211], a[176:179], v[64:67]
    buffer_load_dwordx4 v237, s[20:23], s63 offen lds
    s_waitcnt lgkmcnt(1)
    v_mfma_f32_16x16x32_bf16 v[28:31], a[52:55], v[212:215], v[28:31]
    ds_read_b128 v[220:223], v225 offset:64512
    v_mfma_f32_16x16x32_bf16 v[44:47], a[116:119], v[212:215], v[44:47]
    s_add_u32 m0, s61, 141312
    v_mfma_f32_16x16x32_bf16 v[64:67], v[212:215], a[180:183], v[64:67]
    buffer_load_dwordx4 v238, s[20:23], s63 offen lds
    s_waitcnt lgkmcnt(1)
    v_mfma_f32_16x16x32_bf16 v[28:31], a[56:59], v[216:219], v[28:31]
    v_mfma_f32_16x16x32_bf16 v[44:47], a[120:123], v[216:219], v[44:47]
    v_mfma_f32_16x16x32_bf16 v[64:67], v[216:219], a[184:187], v[64:67]
    s_waitcnt lgkmcnt(0)
    v_mfma_f32_16x16x32_bf16 v[28:31], a[60:63], v[220:223], v[28:31]
    v_mfma_f32_16x16x32_bf16 v[44:47], a[124:127], v[220:223], v[44:47]
    v_mfma_f32_16x16x32_bf16 v[64:67], v[220:223], a[188:191], v[64:67]
    s_barrier
    s_mov_b32 s100, 1
    s_cmp_lg_u32 s2, 0
    s_cbranch_scc1 L_noepi_7
    s_cmp_lg_u32 s3, 3
    s_cbranch_scc1 L_noepi_7
    s_mov_b32 s100, 0
    v_bfe_u32 v228, v0, 3, 2
    v_lshlrev_b32 v228, 7, v228
    v_and_b32 v15, 7, v0
    v_lshl_add_u32 v228, v15, 2, v228
    v_lshrrev_b32 v229, 5, v0
    v_lshl_add_u32 v228, v229, 9, v228
    s_mov_b32 s24, 36864
    buffer_load_dword v224, v228, s[12:15], s24 offen offset:0 sc1
    buffer_load_dword v225, v228, s[12:15], s24 offen offset:1024 sc1
    buffer_load_dword v226, v228, s[12:15], s24 offen offset:2048 sc1
    buffer_load_dword v227, v228, s[12:15], s24 offen offset:3072 sc1
L_noepi_7:
    v_and_b32 v12, 15, v0
    v_lshlrev_b32 v12, 1, v12
    v_bfe_u32 v15, v0, 4, 1
    v_or_b32 v12, v12, v15
    v_lshlrev_b32 v12, 10, v12
    v_lshrrev_b32 v13, 5, v0
    v_lshl_add_u32 v12, v13, 3, v12
    buffer_load_dwordx2 v[244:245], v12, s[8:11], s86 offen offset:0
    buffer_load_dwordx2 v[246:247], v12, s[8:11], s86 offen offset:16
    buffer_load_dwordx2 v[248:249], v12, s[8:11], s86 offen offset:32
    buffer_load_dwordx2 v[250:251], v12, s[8:11], s86 offen offset:48
    s_add_u32 s63, s60, 458752
    v_mov_b32 v142, 0x3f803f80
    v_mov_b32 v143, 0x3f803f80
    v_mov_b32 v144, 0x3f803f80
    v_mov_b32 v145, 0x3f803f80
    v_cvt_pk_bf16_f32 v112, v16, v17
    v_cvt_pk_bf16_f32 v113, v18, v19
    v_cvt_pk_bf16_f32 v114, v20, v21
    v_cvt_pk_bf16_f32 v115, v22, v23
    v_cvt_pk_bf16_f32 v116, v24, v25
    v_cvt_pk_bf16_f32 v117, v26, v27
    v_cvt_pk_bf16_f32 v118, v28, v29
    v_cvt_pk_bf16_f32 v119, v30, v31
    s_add_u32 m0, s61, 0
    v_cvt_pk_bf16_f32 v120, v32, v33
    v_cvt_pk_bf16_f32 v121, v34, v35
    v_cvt_pk_bf16_f32 v122, v36, v37
    v_cvt_pk_bf16_f32 v123, v38, v39
    v_cvt_pk_bf16_f32 v124, v40, v41
    v_cvt_pk_bf16_f32 v125, v42, v43
    v_cvt_pk_bf16_f32 v126, v44, v45
    v_cvt_pk_bf16_f32 v127, v46, v47
    v_cvt_pk_bf16_f32 v128, v48, v49
    v_cvt_pk_bf16_f32 v129, v50, v51
    s_nop 1
    v_mfma_f32_16x16x16_bf16 v[146:149], v[128:129], v[112:113], v[200:203]
    v_mfma_f32_16x16x16_bf16 v[150:153], v[120:121], v[112:113], v[192:195]
    buffer_load_dwordx4 v232, s[20:23], s63 offen lds
    v_mfma_f32_16x16x16_bf16 v[154:157], v[128:129], v[114:115], v[204:207]
    v_mfma_f32_16x16x16_bf16 v[158:161], v[122:123], v[114:115], v[192:195]
    v_mfma_f32_16x16x16_bf16 v[162:165], v[120:121], v[116:117], v[196:199]
    v_mfma_f32_16x16x16_bf16 v[166:169], v[124:125], v[116:117], v[192:195]
    v_mfma_f32_16x16x16_bf16 v[170:173], v[122:123], v[118:119], v[196:199]
    v_mfma_f32_16x16x16_bf16 v[174:177], v[126:127], v[118:119], v[192:195]
    v_cvt_pk_bf16_f32 v130, v68, v69
    v_cvt_pk_bf16_f32 v131, v70, v71
    v_cvt_pk_bf16_f32 v132, v52, v53
    v_cvt_pk_bf16_f32 v133, v54, v55
    v_cvt_pk_bf16_f32 v134, v60, v61
    v_cvt_pk_bf16_f32 v135, v62, v63
    s_add_u32 m0, s61, 1024
    v_cvt_pk_bf16_f32 v136, v68, v69
    v_cvt_pk_bf16_f32 v137, v70, v71
    v_cvt_pk_bf16_f32 v138, v56, v57
    v_cvt_pk_bf16_f32 v139, v58, v59
    v_cvt_pk_bf16_f32 v140, v64, v65
    v_cvt_pk_bf16_f32 v141, v66, v67
    v_max3_f32 v178, v146, v147, v148
    v_max3_f32 v179, v154, v155, v156
    v_max3_f32 v180, v162, v163, v164
    v_max3_f32 v181, v170, v171, v172
    v_max3_f32 v178, v178, v149, v150
    v_max3_f32 v179, v179, v157, v158
    buffer_load_dwordx4 v233, s[20:23], s63 offen lds
    v_max3_f32 v180, v180, v165, v166
    v_max3_f32 v181, v181, v173, v174
    v_max3_f32 v178, v178, v151, v152
    v_max3_f32 v179, v179, v159, v160
    v_max3_f32 v180, v180, v167, v168
    v_max3_f32 v181, v181, v175, v176
    v_max_f32 v178, v178, v153
    v_max_f32 v179, v179, v161
    v_max_f32 v180, v180, v169
    v_max_f32 v181, v181, v177
    v_mov_b32 v182, v178
    v_mov_b32 v183, v179
    s_add_u32 m0, s61, 2048
    v_mov_b32 v184, v180
    v_mov_b32 v185, v181
    v_permlane32_swap_b32 v182, v178
    v_permlane32_swap_b32 v183, v179
    v_permlane32_swap_b32 v184, v180
    v_permlane32_swap_b32 v185, v181
    v_max_f32 v178, v178, v182
    v_max_f32 v179, v179, v183
    v_max_f32 v180, v180, v184
    v_max_f32 v181, v181, v185
    v_mov_b32 v182, v178
    v_mov_b32 v183, v179
    buffer_load_dwordx4 v234, s[20:23], s63 offen lds
    v_mov_b32 v184, v180
    v_mov_b32 v185, v181
    v_permlane16_swap_b32 v182, v178
    v_permlane16_swap_b32 v183, v179
    v_permlane16_swap_b32 v184, v180
    v_permlane16_swap_b32 v185, v181
    v_max_f32 v178, v178, v182
    v_max_f32 v179, v179, v183
    v_max_f32 v180, v180, v184
    v_max_f32 v181, v181, v185
    v_mov_b32 v186, 0x3eb8aa3b
    v_mul_f32 v178, 0xbeb8aa3b, v178
    s_add_u32 m0, s61, 3072
    v_mul_f32 v179, 0xbeb8aa3b, v179
    v_mul_f32 v180, 0xbeb8aa3b, v180
    v_mul_f32 v181, 0xbeb8aa3b, v181
    v_pk_fma_f32 v[146:147], v[146:147], v[186:187], v[178:179] op_sel:[0,0,0] op_sel_hi:[1,0,0]
    v_pk_fma_f32 v[148:149], v[148:149], v[186:187], v[178:179] op_sel:[0,0,0] op_sel_hi:[1,0,0]
    v_pk_fma_f32 v[150:151], v[150:151], v[186:187], v[178:179] op_sel:[0,0,0] op_sel_hi:[1,0,0]
    v_pk_fma_f32 v[152:153], v[152:153], v[186:187], v[178:179] op_sel:[0,0,0] op_sel_hi:[1,0,0]
    v_pk_fma_f32 v[154:155], v[154:155], v[186:187], v[178:179] op_sel:[0,0,1] op_sel_hi:[1,0,1]
    v_pk_fma_f32 v[156:157], v[156:157], v[186:187], v[178:179] op_sel:[0,0,1] op_sel_hi:[1,0,1]
    v_pk_fma_f32 v[158:159], v[158:159], v[186:187], v[178:179] op_sel:[0,0,1] op_sel_hi:[1,0,1]
    v_pk_fma_f32 v[160:161], v[160:161], v[186:187], v[178:179] op_sel:[0,0,1] op_sel_hi:[1,0,1]
    v_pk_fma_f32 v[162:163], v[162:163], v[186:187], v[180:181] op_sel:[0,0,0] op_sel_hi:[1,0,0]
    buffer_load_dwordx4 v235, s[20:23], s63 offen lds
    v_pk_fma_f32 v[164:165], v[164:165], v[186:187], v[180:181] op_sel:[0,0,0] op_sel_hi:[1,0,0]
    v_pk_fma_f32 v[166:167], v[166:167], v[186:187], v[180:181] op_sel:[0,0,0] op_sel_hi:[1,0,0]
    v_pk_fma_f32 v[168:169], v[168:169], v[186:187], v[180:181] op_sel:[0,0,0] op_sel_hi:[1,0,0]
    v_pk_fma_f32 v[170:171], v[170:171], v[186:187], v[180:181] op_sel:[0,0,1] op_sel_hi:[1,0,1]
    v_pk_fma_f32 v[172:173], v[172:173], v[186:187], v[180:181] op_sel:[0,0,1] op_sel_hi:[1,0,1]
    v_pk_fma_f32 v[174:175], v[174:175], v[186:187], v[180:181] op_sel:[0,0,1] op_sel_hi:[1,0,1]
    v_pk_fma_f32 v[176:177], v[176:177], v[186:187], v[180:181] op_sel:[0,0,1] op_sel_hi:[1,0,1]
    v_exp_f32 v146, v146
    v_exp_f32 v147, v147
    v_exp_f32 v148, v148
    v_exp_f32 v149, v149
    v_exp_f32 v150, v150
    s_add_u32 m0, s61, 4096
    v_exp_f32 v151, v151
    v_exp_f32 v152, v152
    v_exp_f32 v153, v153
    v_cvt_pk_bf16_f32 v208, v146, v147
    v_cvt_pk_bf16_f32 v209, v148, v149
    v_cvt_pk_bf16_f32 v210, v150, v151
    v_cvt_pk_bf16_f32 v211, v152, v153
    s_nop 1
    v_mfma_f32_16x16x32_bf16 v[88:91], v[142:145], v[208:211], 0
    v_mfma_f32_16x16x32_bf16 v[72:75], v[130:133], v[208:211], 0
    v_exp_f32 v154, v154
    v_exp_f32 v155, v155
    v_exp_f32 v156, v156
    buffer_load_dwordx4 v236, s[20:23], s63 offen lds
    v_exp_f32 v157, v157
    v_exp_f32 v158, v158
    v_exp_f32 v159, v159
    v_exp_f32 v160, v160
    v_exp_f32 v161, v161
    v_cvt_pk_bf16_f32 v212, v154, v155
    v_cvt_pk_bf16_f32 v213, v156, v157
    v_cvt_pk_bf16_f32 v214, v158, v159
    v_cvt_pk_bf16_f32 v215, v160, v161
    s_nop 1
    v_mfma_f32_16x16x32_bf16 v[92:95], v[142:145], v[212:215], 0
    v_mfma_f32_16x16x32_bf16 v[76:79], v[136:139], v[212:215], 0
    v_exp_f32 v162, v162
    s_add_u32 m0, s61, 5120
    v_exp_f32 v163, v163
    v_exp_f32 v164, v164
    v_exp_f32 v165, v165
    v_exp_f32 v166, v166
    v_exp_f32 v167, v167
    v_exp_f32 v168, v168
    v_exp_f32 v169, v169
    v_cvt_pk_bf16_f32 v216, v162, v163
    v_cvt_pk_bf16_f32 v217, v164, v165
    v_cvt_pk_bf16_f32 v218, v166, v167
    v_cvt_pk_bf16_f32 v219, v168, v169
    s_nop 1
    v_mfma_f32_16x16x32_bf16 v[96:99], v[142:145], v[216:219], 0
    buffer_load_dwordx4 v237, s[20:23], s63 offen lds
    v_mfma_f32_16x16x32_bf16 v[80:83], v[132:135], v[216:219], 0
    v_exp_f32 v170, v170
    v_exp_f32 v171, v171
    v_exp_f32 v172, v172
    v_exp_f32 v173, v173
    v_exp_f32 v174, v174
    v_exp_f32 v175, v175
    v_exp_f32 v176, v176
    v_exp_f32 v177, v177
    v_cvt_pk_bf16_f32 v220, v170, v171
    v_cvt_pk_bf16_f32 v221, v172, v173
    v_cvt_pk_bf16_f32 v222, v174, v175
    s_add_u32 m0, s61, 6144
    v_cvt_pk_bf16_f32 v223, v176, v177
    s_nop 1
    v_mfma_f32_16x16x32_bf16 v[100:103], v[142:145], v[220:223], 0
    v_mfma_f32_16x16x32_bf16 v[84:87], v[138:141], v[220:223], 0
    v_rcp_f32 v88, v88
    v_rcp_f32 v92, v92
    v_rcp_f32 v96, v96
    s_nop 3
    v_rcp_f32 v100, v100
    v_pk_mul_f32 v[72:73], v[72:73], v[88:89] op_sel_hi:[1,0]
    v_pk_mul_f32 v[74:75], v[74:75], v[88:89] op_sel_hi:[1,0]
    v_pk_mul_f32 v[76:77], v[76:77], v[92:93] op_sel_hi:[1,0]
    v_pk_mul_f32 v[78:79], v[78:79], v[92:93] op_sel_hi:[1,0]
    v_pk_mul_f32 v[80:81], v[80:81], v[96:97] op_sel_hi:[1,0]
    buffer_load_dwordx4 v238, s[20:23], s63 offen lds
    v_pk_mul_f32 v[82:83], v[82:83], v[96:97] op_sel_hi:[1,0]
    v_pk_mul_f32 v[84:85], v[84:85], v[100:101] op_sel_hi:[1,0]
    v_pk_mul_f32 v[86:87], v[86:87], v[100:101] op_sel_hi:[1,0]
    v_cvt_pk_bf16_f32 v104, v72, v73
    v_cvt_pk_bf16_f32 v105, v74, v75
    v_cvt_pk_bf16_f32 v106, v76, v77
    v_cvt_pk_bf16_f32 v107, v78, v79
    v_cvt_pk_bf16_f32 v108, v80, v81
    v_cvt_pk_bf16_f32 v109, v82, v83
    v_cvt_pk_bf16_f32 v110, v84, v85
    v_cvt_pk_bf16_f32 v111, v86, v87
    v_bfe_u32 v12, v0, 4, 1
    v_lshlrev_b32 v12, 5, v12
    v_lshrrev_b32 v13, 5, v0
    v_lshl_or_b32 v12, v13, 4, v12
    v_and_b32 v13, 15, v0
    v_or_b32 v12, v12, v13
    v_lshlrev_b32 v12, 4, v12
    v_permlane32_swap_b32 v104, v106
    v_permlane32_swap_b32 v105, v107
    v_permlane32_swap_b32 v108, v110
    v_permlane32_swap_b32 v109, v111
    buffer_store_dwordx4 v[104:107], v12, s[12:15], s73 offen sc1
    buffer_store_dwordx4 v[108:111], v12, s[12:15], s74 offen sc1
    v_lshrrev_b32 v11, 5, v0
    v_lshlrev_b32 v11, 4, v11
    s_lshl_b32 s28, s93, 7
    s_add_u32 s28, s28, 86016
    v_add_u32 v11, s28, v11
    ds_read_b128 v[192:195], v11 offset:0
    ds_read_b128 v[196:199], v11 offset:32
    ds_read_b128 v[200:203], v11 offset:64
    ds_read_b128 v[204:207], v11 offset:96
    ds_read_b128 v[160:163], v11 offset:256
    ds_read_b128 v[164:167], v11 offset:288
    ds_read_b128 v[168:171], v11 offset:320
    ds_read_b128 v[172:175], v11 offset:352
    ds_read_b128 v[176:179], v11 offset:512
    ds_read_b128 v[180:183], v11 offset:544
    ds_read_b128 v[184:187], v11 offset:576
    ds_read_b128 v[188:191], v11 offset:608
    ds_read_b128 v[144:147], v11 offset:768
    ds_read_b128 v[148:151], v11 offset:800
    ds_read_b128 v[152:155], v11 offset:832
    ds_read_b128 v[156:159], v11 offset:864
    s_waitcnt lgkmcnt(0)
    v_mov_b32 v3, s96
    v_mov_b32 v2, 0
    s_waitcnt vmcnt(0)
    s_cmp_eq_u32 s97, 0
    s_cbranch_scc1 L_sigg_8
    s_mov_b64 exec, 1
    buffer_store_dword v3, v2, s[12:15], s94 offen
    s_mov_b64 exec, -1
    s_branch L_sigd_9
L_sigg_8:
    s_barrier
    s_cmp_lg_u32 s3, 0
    s_cbranch_scc1 L_sigd_9
    v_lshlrev_b32 v2, 2, v0
    s_mov_b64 exec, 15
    buffer_store_dword v3, v2, s[12:15], s94 offen sc1
    s_mov_b64 exec, -1
L_sigd_9:
    v_and_b32 v12, 3, v0
    s_lshl_b32 s24, s5, 2
    v_add_u32 v13, s24, v12
    s_and_b32 s25, s4, 1
    s_lshl_b32 s25, s25, 5
    v_add_u32 v14, s25, v13
    v_cmp_gt_u32 vcc, 8, v0
    s_lshl_b32 s24, s3, 3
    v_and_b32 v15, 7, v0
    v_add_u32 v15, s24, v15
    v_cndmask_b32 v4, v13, v15, vcc
    v_lshlrev_b32 v4, 2, v4
    v_bfe_u32 v15, v0, 1, 2
    s_lshl_b32 s24, s3, 2
    v_add_u32 v15, s24, v15
    v_and_b32 v13, 1, v15
    v_lshlrev_b32 v13, 3, v13
    v_lshrrev_b32 v15, 1, v15
    v_add_u32 v15, v15, v13
    v_and_b32 v13, 1, v0
    s_and_b32 s24, s4, 1
    s_lshl_b32 s24, s24, 1
    v_add_u32 v13, s24, v13
    v_lshl_add_u32 v15, v15, 2, v13
    v_cndmask_b32 v6, v14, v15, vcc
    v_lshlrev_b32 v6, 2, v6
    v_bfe_u32 v15, v0, 1, 3
    s_bfe_u32 s24, s6, 0x10001
    s_lshl_b32 s24, s24, 3
    v_add_u32 v15, s24, v15
    s_and_b32 s24, s6, 1
    s_lshl_b32 s24, s24, 1
    v_and_b32 v13, 1, v0
    v_add_u32 v13, s24, v13
    v_lshl_add_u32 v15, v15, 2, v13
    v_lshlrev_b32 v5, 2, v15
    s_lshl_b32 s25, s3, 3
    s_xor_b32 s24, s92, 0
    s_lshl_b32 s24, s24, 5
    s_add_u32 s24, s24, s25
    s_lshl_b32 s24, s24, 10
    s_add_u32 s75, s24, 1048576
    s_add_u32 s77, s75, 4096
    s_xor_b32 s24, s92, 1
    s_lshl_b32 s24, s24, 5
    s_add_u32 s24, s24, s25
    s_lshl_b32 s24, s24, 10
    s_add_u32 s76, s24, 1048576
    s_add_u32 s78, s76, 4096
    s_lshl_b32 s24, s92, 4
    s_lshl_b32 s25, s5, 1
    s_add_u32 s25, s25, s24
    s_add_u32 s25, s25, s93
    s_lshl_b32 s25, s25, 9
    s_add_u32 s79, s25, 524288
    s_lshl_b32 s24, s24, 9
    s_add_u32 s80, s24, 524288
    s_lshl_b32 s24, s92, 5
    s_lshl_b32 s25, s5, 2
    s_add_u32 s24, s24, s25
    s_lshl_b32 s25, s93, 1
    s_add_u32 s24, s24, s25
    s_lshl_b32 s24, s24, 10
    s_add_u32 s81, s24, 3145728
    s_mul_i32 s24, s6, 112
    s_mul_i32 s25, s33, 7
    s_add_u32 s24, s24, s25
    s_lshl_b32 s24, s24, 10
    s_add_u32 s82, s24, 6291456
    s_add_u32 s83, s82, 4096
    s_mul_i32 s25, s3, 28
    s_xor_b32 s24, s92, 0
    s_mul_i32 s24, s24, 112
    s_add_u32 s24, s24, s25
    s_lshl_b32 s24, s24, 10
    s_add_u32 s84, s24, 6291456
    s_xor_b32 s24, s92, 1
    s_mul_i32 s24, s24, 112
    s_add_u32 s24, s24, s25
    s_lshl_b32 s24, s24, 10
    s_add_u32 s85, s24, 6291456
    s_lshr_b32 s88, s4, 1
    s_lshl_b32 s88, s88, 8
    s_add_u32 s88, s88, 4096
    s_lshr_b32 s89, s4, 1
    s_lshl_b32 s89, s89, 8
    s_add_u32 s89, s89, 8192
    s_lshl_b32 s24, s5, 2
    s_add_u32 s24, s24, s3
    s_lshl_b32 s24, s24, 2
    s_and_b32 s25, s4, 1
    s_lshl_b32 s25, s25, 7
    s_add_u32 s24, s24, s25
    s_add_u32 s95, s88, s24
    s_add_u32 s90, s89, s24
    v_mov_b32 v2, 0xbfb8aa3b
    v_mov_b32 v12, 0xbf317218
    v_pk_mul_f32 v[160:161], v[160:161], v[2:3] op_sel_hi:[1,0]
    v_pk_mul_f32 v[162:163], v[162:163], v[2:3] op_sel_hi:[1,0]
    v_pk_mul_f32 v[164:165], v[164:165], v[2:3] op_sel_hi:[1,0]
    v_pk_mul_f32 v[166:167], v[166:167], v[2:3] op_sel_hi:[1,0]
    v_pk_mul_f32 v[168:169], v[168:169], v[2:3] op_sel_hi:[1,0]
    v_pk_mul_f32 v[170:171], v[170:171], v[2:3] op_sel_hi:[1,0]
    v_pk_mul_f32 v[172:173], v[172:173], v[2:3] op_sel_hi:[1,0]
    v_pk_mul_f32 v[174:175], v[174:175], v[2:3] op_sel_hi:[1,0]
    v_pk_mul_f32 v[176:177], v[176:177], v[2:3] op_sel_hi:[1,0]
    v_pk_mul_f32 v[178:179], v[178:179], v[2:3] op_sel_hi:[1,0]
    v_pk_mul_f32 v[180:181], v[180:181], v[2:3] op_sel_hi:[1,0]
    v_pk_mul_f32 v[182:183], v[182:183], v[2:3] op_sel_hi:[1,0]
    v_pk_mul_f32 v[184:185], v[184:185], v[2:3] op_sel_hi:[1,0]
    v_pk_mul_f32 v[186:187], v[186:187], v[2:3] op_sel_hi:[1,0]
    v_pk_mul_f32 v[188:189], v[188:189], v[2:3] op_sel_hi:[1,0]
    v_pk_mul_f32 v[190:191], v[190:191], v[2:3] op_sel_hi:[1,0]
    v_pk_mul_f32 v[144:145], v[144:145], v[12:13] op_sel_hi:[1,0]
    v_pk_mul_f32 v[146:147], v[146:147], v[12:13] op_sel_hi:[1,0]
    v_pk_mul_f32 v[148:149], v[148:149], v[12:13] op_sel_hi:[1,0]
    v_pk_mul_f32 v[150:151], v[150:151], v[12:13] op_sel_hi:[1,0]
    v_pk_mul_f32 v[152:153], v[152:153], v[12:13] op_sel_hi:[1,0]
    v_pk_mul_f32 v[154:155], v[154:155], v[12:13] op_sel_hi:[1,0]
    v_pk_mul_f32 v[156:157], v[156:157], v[12:13] op_sel_hi:[1,0]
    v_pk_mul_f32 v[158:159], v[158:159], v[12:13] op_sel_hi:[1,0]
    s_xor_b32 s24, s3, 1
    s_mul_i32 s24, s24, 12288
    s_add_u32 s24, s24, 57344
    v_add_u32 v13, s24, v1
    s_xor_b32 s24, s3, 2
    s_mul_i32 s24, s24, 12288
    s_add_u32 s24, s24, 61440
    v_add_u32 v14, s24, v1
    s_xor_b32 s24, s3, 3
    s_mul_i32 s24, s24, 12288
    s_add_u32 s24, s24, 65536
    v_add_u32 v15, s24, v1
    s_mul_i32 s24, s3, 12288
    s_add_u32 s24, s24, 57344
    v_add_u32 v12, s24, v1
    v_and_b32 v10, 31, v0
    v_lshlrev_b32 v10, 4, v10
    v_lshrrev_b32 v9, 5, v0
    v_lshl_add_u32 v9, v9, 12, v10
    s_mov_b32 s101, 0
L_spin_10:
    buffer_load_dword v3, v4, s[12:15], s87 offen sc1
    s_waitcnt vmcnt(0)
    v_cmp_eq_u32 vcc, s96, v3
    s_nop 0
    s_cmp_eq_u64 vcc, exec
    s_cbranch_scc1 L_spun_11
    s_add_u32 s101, s101, 1
    s_cmp_lt_u32 s101, 1048576
    s_cbranch_scc1 L_spin_10
L_spun_11:
    s_cmp_eq_u32 s100, 1
    s_cbranch_scc1 L_noepc_12
    s_and_b32 s27, s96, 0x0fffffff
    v_lshrrev_b32 v224, 4, v224
    v_lshrrev_b32 v225, 4, v225
    v_lshrrev_b32 v226, 4, v226
    v_lshrrev_b32 v227, 4, v227
    v_cmp_eq_u32 vcc, s27, v224
    v_cmp_eq_u32 s[28:29], s27, v225
    s_nop 0
    s_and_b64 vcc, vcc, s[28:29]
    v_cmp_eq_u32 s[28:29], s27, v226
    s_nop 0
    s_and_b64 vcc, vcc, s[28:29]
    v_cmp_eq_u32 s[28:29], s27, v227
    s_nop 0
    s_and_b64 vcc, vcc, s[28:29]
    s_cmp_eq_u64 vcc, exec
    s_cbranch_scc0 L_noepc_12
    s_mov_b32 s100, 1
    v_mov_b32 v224, 0
    v_mov_b32 v225, s96
    s_mov_b32 s26, 32768
    buffer_store_dword v225, v224, s[12:15], s26 offen sc1
L_noepc_12:
    buffer_load_dwordx4 v[80:83], v1, s[12:15], s75 offen offset:0 sc1
    buffer_load_dwordx4 v[112:115], v1, s[12:15], s76 offen offset:0 sc1
    buffer_load_dwordx4 v[84:87], v1, s[12:15], s75 offen offset:1024 sc1
    buffer_load_dwordx4 v[116:119], v1, s[12:15], s76 offen offset:1024 sc1
    buffer_load_dwordx4 v[88:91], v1, s[12:15], s75 offen offset:2048 sc1
    buffer_load_dwordx4 v[120:123], v1, s[12:15], s76 offen offset:2048 sc1
    buffer_load_dwordx4 v[92:95], v1, s[12:15], s75 offen offset:3072 sc1
    buffer_load_dwordx4 v[124:127], v1, s[12:15], s76 offen offset:3072 sc1
    s_waitcnt vmcnt(7)
    v_mfma_f32_32x32x16_bf16 v[16:31], a[192:195], v[80:83], 0
    buffer_load_dwordx4 v[96:99], v1, s[12:15], s77 offen offset:0 sc1
    s_waitcnt vmcnt(7)
    v_mfma_f32_32x32x16_bf16 v[32:47], a[192:195], v[112:115], 0
    v_mfma_f32_32x32x16_bf16 v[48:63], a[196:199], v[80:83], 0
    buffer_load_dwordx4 v[128:131], v1, s[12:15], s78 offen offset:0 sc1
    v_mfma_f32_32x32x16_bf16 v[64:79], a[196:199], v[112:115], 0
    s_waitcnt vmcnt(7)
    v_mfma_f32_32x32x16_bf16 v[16:31], a[200:203], v[84:87], v[16:31]
    buffer_load_dwordx4 v[100:103], v1, s[12:15], s77 offen offset:1024 sc1
    s_waitcnt vmcnt(7)
    v_mfma_f32_32x32x16_bf16 v[32:47], a[200:203], v[116:119], v[32:47]
    v_mfma_f32_32x32x16_bf16 v[48:63], a[204:207], v[84:87], v[48:63]
    buffer_load_dwordx4 v[132:135], v1, s[12:15], s78 offen offset:1024 sc1
    v_mfma_f32_32x32x16_bf16 v[64:79], a[204:207], v[116:119], v[64:79]
    s_waitcnt vmcnt(7)
    v_mfma_f32_32x32x16_bf16 v[16:31], a[208:211], v[88:91], v[16:31]
    buffer_load_dwordx4 v[104:107], v1, s[12:15], s77 offen offset:2048 sc1
    s_waitcnt vmcnt(7)
    v_mfma_f32_32x32x16_bf16 v[32:47], a[208:211], v[120:123], v[32:47]
    v_mfma_f32_32x32x16_bf16 v[48:63], a[212:215], v[88:91], v[48:63]
    buffer_load_dwordx4 v[136:139], v1, s[12:15], s78 offen offset:2048 sc1
    v_mfma_f32_32x32x16_bf16 v[64:79], a[212:215], v[120:123], v[64:79]
    s_waitcnt vmcnt(7)
    v_mfma_f32_32x32x16_bf16 v[16:31], a[216:219], v[92:95], v[16:31]
    buffer_load_dwordx4 v[108:111], v1, s[12:15], s77 offen offset:3072 sc1
    s_waitcnt vmcnt(7)
    v_mfma_f32_32x32x16_bf16 v[32:47], a[216:219], v[124:127], v[32:47]
    v_mfma_f32_32x32x16_bf16 v[48:63], a[220:223], v[92:95], v[48:63]
    buffer_load_dwordx4 v[140:143], v1, s[12:15], s78 offen offset:3072 sc1
    v_mfma_f32_32x32x16_bf16 v[64:79], a[220:223], v[124:127], v[64:79]
    s_waitcnt vmcnt(7)
    v_mfma_f32_32x32x16_bf16 v[16:31], a[224:227], v[96:99], v[16:31]
    s_add_u32 s63, s60, 688128
    s_add_u32 m0, s61, 28672
    s_waitcnt vmcnt(6)
    v_mfma_f32_32x32x16_bf16 v[32:47], a[224:227], v[128:131], v[32:47]
    buffer_load_dwordx4 v232, s[20:23], s63 offen lds
    v_mfma_f32_32x32x16_bf16 v[48:63], a[228:231], v[96:99], v[48:63]
    s_add_u32 m0, s61, 29696
    v_mfma_f32_32x32x16_bf16 v[64:79], a[228:231], v[128:131], v[64:79]
    buffer_load_dwordx4 v233, s[20:23], s63 offen lds
    s_waitcnt vmcnt(7)
    v_mfma_f32_32x32x16_bf16 v[16:31], a[232:235], v[100:103], v[16:31]
    s_add_u32 m0, s61, 30720
    s_waitcnt vmcnt(6)
    v_mfma_f32_32x32x16_bf16 v[32:47], a[232:235], v[132:135], v[32:47]
    buffer_load_dwordx4 v234, s[20:23], s63 offen lds
    v_mfma_f32_32x32x16_bf16 v[48:63], a[236:239], v[100:103], v[48:63]
    s_add_u32 m0, s61, 31744
    v_mfma_f32_32x32x16_bf16 v[64:79], a[236:239], v[132:135], v[64:79]
    buffer_load_dwordx4 v235, s[20:23], s63 offen lds
    s_waitcnt vmcnt(7)
    v_mfma_f32_32x32x16_bf16 v[16:31], a[240:243], v[104:107], v[16:31]
    s_add_u32 m0, s61, 32768
    s_waitcnt vmcnt(6)
    v_mfma_f32_32x32x16_bf16 v[32:47], a[240:243], v[136:139], v[32:47]
    buffer_load_dwordx4 v236, s[20:23], s63 offen lds
    v_mfma_f32_32x32x16_bf16 v[48:63], a[244:247], v[104:107], v[48:63]
    s_add_u32 m0, s61, 33792
    v_mfma_f32_32x32x16_bf16 v[64:79], a[244:247], v[136:139], v[64:79]
    buffer_load_dwordx4 v237, s[20:23], s63 offen lds
    s_waitcnt vmcnt(6)
    v_mfma_f32_32x32x16_bf16 v[64:79], a[252:255], v[140:143], v[64:79]
    s_add_u32 m0, s61, 34816
    v_mfma_f32_32x32x16_bf16 v[48:63], a[252:255], v[108:111], v[48:63]
    v_mfma_f32_32x32x16_bf16 v[32:47], a[248:251], v[140:143], v[32:47]
    buffer_load_dwordx4 v238, s[20:23], s63 offen lds
    v_mfma_f32_32x32x16_bf16 v[16:31], a[248:251], v[108:111], v[16:31]
    s_nop 8
    ds_write_b128 v13, v[48:51] offset:0
    ds_write_b128 v13, v[52:55] offset:1024
    ds_write_b128 v13, v[56:59] offset:2048
    ds_write_b128 v13, v[60:63] offset:3072
    ds_write_b128 v14, v[32:35] offset:0
    ds_write_b128 v14, v[36:39] offset:1024
    ds_write_b128 v14, v[40:43] offset:2048
    ds_write_b128 v14, v[44:47] offset:3072
    ds_write_b128 v15, v[64:67] offset:0
    ds_write_b128 v15, v[68:71] offset:1024
    ds_write_b128 v15, v[72:75] offset:2048
    ds_write_b128 v15, v[76:79] offset:3072
    s_waitcnt lgkmcnt(0)
    s_barrier
    ds_read_b128 v[32:35], v12 offset:0
    ds_read_b128 v[36:39], v12 offset:1024
    ds_read_b128 v[40:43], v12 offset:2048
    ds_read_b128 v[44:47], v12 offset:3072
    ds_read_b128 v[48:51], v12 offset:4096
    ds_read_b128 v[52:55], v12 offset:5120
    ds_read_b128 v[56:59], v12 offset:6144
    ds_read_b128 v[60:63], v12 offset:7168
    ds_read_b128 v[64:67], v12 offset:8192
    ds_read_b128 v[68:71], v12 offset:9216
    ds_read_b128 v[72:75], v12 offset:10240
    ds_read_b128 v[76:79], v12 offset:11264
    s_waitcnt lgkmcnt(11)
    v_pk_add_f32 v[16:17], v[16:17], v[32:33]
    v_pk_add_f32 v[18:19], v[18:19], v[34:35]
    s_waitcnt lgkmcnt(10)
    v_pk_add_f32 v[20:21], v[20:21], v[36:37]
    v_pk_add_f32 v[22:23], v[22:23], v[38:39]
    s_waitcnt lgkmcnt(9)
    v_pk_add_f32 v[24:25], v[24:25], v[40:41]
    v_pk_add_f32 v[26:27], v[26:27], v[42:43]
    s_waitcnt lgkmcnt(8)
    v_pk_add_f32 v[28:29], v[28:29], v[44:45]
    v_pk_add_f32 v[30:31], v[30:31], v[46:47]
    s_waitcnt lgkmcnt(3)
    v_pk_add_f32 v[48:49], v[48:49], v[64:65]
    v_pk_add_f32 v[50:51], v[50:51], v[66:67]
    s_waitcnt lgkmcnt(2)
    v_pk_add_f32 v[52:53], v[52:53], v[68:69]
    v_pk_add_f32 v[54:55], v[54:55], v[70:71]
    s_waitcnt lgkmcnt(1)
    v_pk_add_f32 v[56:57], v[56:57], v[72:73]
    v_pk_add_f32 v[58:59], v[58:59], v[74:75]
    s_waitcnt lgkmcnt(0)
    v_pk_add_f32 v[60:61], v[60:61], v[76:77]
    v_pk_add_f32 v[62:63], v[62:63], v[78:79]
    v_pk_add_f32 v[16:17], v[16:17], v[48:49]
    v_pk_add_f32 v[18:19], v[18:19], v[50:51]
    v_pk_add_f32 v[20:21], v[20:21], v[52:53]
    v_pk_add_f32 v[22:23], v[22:23], v[54:55]
    v_pk_add_f32 v[24:25], v[24:25], v[56:57]
    v_pk_add_f32 v[26:27], v[26:27], v[58:59]
    v_pk_add_f32 v[28:29], v[28:29], v[60:61]
    v_pk_add_f32 v[30:31], v[30:31], v[62:63]
    v_lshlrev_b32 v32, 16, v244
    v_and_b32 v33, s7, v244
    v_lshlrev_b32 v34, 16, v245
    v_and_b32 v35, s7, v245
    v_lshlrev_b32 v36, 16, v246
    v_and_b32 v37, s7, v246
    v_lshlrev_b32 v38, 16, v247
    v_and_b32 v39, s7, v247
    v_lshlrev_b32 v40, 16, v248
    v_and_b32 v41, s7, v248
    v_lshlrev_b32 v42, 16, v249
    v_and_b32 v43, s7, v249
    v_lshlrev_b32 v44, 16, v250
    v_and_b32 v45, s7, v250
    v_lshlrev_b32 v46, 16, v251
    v_and_b32 v47, s7, v251
    v_pk_fma_f32 v[32:33], v[192:193], v[16:17], v[32:33]
    v_pk_fma_f32 v[34:35], v[194:195], v[18:19], v[34:35]
    v_pk_fma_f32 v[36:37], v[196:197], v[20:21], v[36:37]
    v_pk_fma_f32 v[38:39], v[198:199], v[22:23], v[38:39]
    v_pk_fma_f32 v[40:41], v[200:201], v[24:25], v[40:41]
    v_pk_fma_f32 v[42:43], v[202:203], v[26:27], v[42:43]
    v_pk_fma_f32 v[44:45], v[204:205], v[28:29], v[44:45]
    v_pk_fma_f32 v[46:47], v[206:207], v[30:31], v[46:47]
    v_cvt_pk_bf16_f32 v244, v32, v33
    v_cvt_pk_bf16_f32 v245, v34, v35
    v_cvt_pk_bf16_f32 v246, v36, v37
    v_cvt_pk_bf16_f32 v247, v38, v39
    v_cvt_pk_bf16_f32 v248, v40, v41
    v_cvt_pk_bf16_f32 v249, v42, v43
    v_cvt_pk_bf16_f32 v250, v44, v45
    v_cvt_pk_bf16_f32 v251, v46, v47
    v_mov_b32 v48, 0x3f803f80
    v_dot2_f32_bf16 v52, v244, v48, 0
    v_dot2_f32_bf16 v53, v244, v244, 0
    s_nop 1
    v_dot2c_f32_bf16 v52, v245, v48
    v_dot2c_f32_bf16 v53, v245, v245
    v_dot2c_f32_bf16 v52, v246, v48
    v_dot2c_f32_bf16 v53, v246, v246
    v_dot2c_f32_bf16 v52, v247, v48
    v_dot2c_f32_bf16 v53, v247, v247
    v_dot2c_f32_bf16 v52, v248, v48
    v_dot2c_f32_bf16 v53, v248, v248
    v_dot2c_f32_bf16 v52, v249, v48
    v_dot2c_f32_bf16 v53, v249, v249
    v_dot2c_f32_bf16 v52, v250, v48
    v_dot2c_f32_bf16 v53, v250, v250
    v_dot2c_f32_bf16 v52, v251, v48
    v_dot2c_f32_bf16 v53, v251, v251
    s_nop 1
    v_mov_b32 v50, v52
    v_mov_b32 v51, v53
    v_mov_b32 v54, s96
    v_mov_b32 v55, 0
    v_permlane32_swap_b32 v50, v52
    v_permlane32_swap_b32 v51, v53
    v_pk_add_f32 v[52:53], v[52:53], v[50:51]
    s_cmp_lg_u32 s97, 0
    s_cbranch_scc1 L_alt_13_b
    buffer_store_dwordx4 v[52:55], v10, s[12:15], s79 offen sc1
    s_branch L_alt_13_e
L_alt_13_b:
    buffer_store_dwordx4 v[52:55], v10, s[12:15], s79 offen
L_alt_13_e:
    v_lshlrev_b32 v32, 16, v244
    v_and_b32 v33, s7, v244
    v_lshlrev_b32 v34, 16, v245
    v_and_b32 v35, s7, v245
    v_lshlrev_b32 v36, 16, v246
    v_and_b32 v37, s7, v246
    v_lshlrev_b32 v38, 16, v247
    v_and_b32 v39, s7, v247
    v_lshlrev_b32 v40, 16, v248
    v_and_b32 v41, s7, v248
    v_lshlrev_b32 v42, 16, v249
    v_and_b32 v43, s7, v249
    v_lshlrev_b32 v44, 16, v250
    v_and_b32 v45, s7, v250
    v_lshlrev_b32 v46, 16, v251
    v_and_b32 v47, s7, v251
    s_mov_b32 s101, 0
L_spin_14:
    buffer_load_dwordx4 v[80:83], v9, s[12:15], s80 offen offset:0 sc1
    buffer_load_dwordx4 v[84:87], v9, s[12:15], s80 offen offset:512 sc1
    buffer_load_dwordx4 v[88:91], v9, s[12:15], s80 offen offset:1024 sc1
    buffer_load_dwordx4 v[92:95], v9, s[12:15], s80 offen offset:1536 sc1
    buffer_load_dwordx4 v[96:99], v9, s[12:15], s80 offen offset:2048 sc1
    buffer_load_dwordx4 v[100:103], v9, s[12:15], s80 offen offset:2560 sc1
    buffer_load_dwordx4 v[104:107], v9, s[12:15], s80 offen offset:3072 sc1
    buffer_load_dwordx4 v[108:111], v9, s[12:15], s80 offen offset:3584 sc1
    s_waitcnt vmcnt(0)
    v_cmp_eq_u32 vcc, s96, v82
    v_cmp_eq_u32 s[28:29], s96, v86
    s_nop 0
    s_and_b64 vcc, vcc, s[28:29]
    v_cmp_eq_u32 s[28:29], s96, v90
    s_nop 0
    s_and_b64 vcc, vcc, s[28:29]
    v_cmp_eq_u32 s[28:29], s96, v94
    s_nop 0
    s_and_b64 vcc, vcc, s[28:29]
    v_cmp_eq_u32 s[28:29], s96, v98
    s_nop 0
    s_and_b64 vcc, vcc, s[28:29]
    v_cmp_eq_u32 s[28:29], s96, v102
    s_nop 0
    s_and_b64 vcc, vcc, s[28:29]
    v_cmp_eq_u32 s[28:29], s96, v106
    s_nop 0
    s_and_b64 vcc, vcc, s[28:29]
    v_cmp_eq_u32 s[28:29], s96, v110
    s_nop 0
    s_and_b64 vcc, vcc, s[28:29]
    s_cmp_eq_u64 vcc, exec
    s_cbranch_scc1 L_spun_15
    s_add_u32 s101, s101, 1
    s_cmp_lt_u32 s101, 1048576
    s_cbranch_scc1 L_spin_14
L_spun_15:
    v_pk_add_f32 v[80:81], v[80:81], v[84:85]
    v_pk_add_f32 v[88:89], v[88:89], v[92:93]
    v_pk_add_f32 v[96:97], v[96:97], v[100:101]
    v_pk_add_f32 v[104:105], v[104:105], v[108:109]
    v_pk_add_f32 v[80:81], v[80:81], v[88:89]
    v_pk_add_f32 v[96:97], v[96:97], v[104:105]
    v_pk_add_f32 v[80:81], v[80:81], v[96:97]
    v_mov_b32 v82, v80
    v_mov_b32 v83, v81
    s_nop 0
    v_permlane32_swap_b32 v82, v80
    v_permlane32_swap_b32 v83, v81
    v_pk_add_f32 v[80:81], v[80:81], v[82:83]
    v_mul_f32 v80, 0x3b000000, v80
    v_mul_f32 v81, 0x3b000000, v81
    v_fma_f32 v81, -v80, v80, v81
    v_max_f32 v81, 0, v81
    v_add_f32 v81, 0x3727c5ac, v81
    v_rsq_f32 v82, v81
    s_nop 0
    v_mul_f32 v83, -v80, v82
    v_pk_fma_f32 v[32:33], v[32:33], v[82:83], v[82:83] op_sel:[0,0,1] op_sel_hi:[1,0,1]
    v_pk_fma_f32 v[34:35], v[34:35], v[82:83], v[82:83] op_sel:[0,0,1] op_sel_hi:[1,0,1]
    v_pk_fma_f32 v[36:37], v[36:37], v[82:83], v[82:83] op_sel:[0,0,1] op_sel_hi:[1,0,1]
    v_pk_fma_f32 v[38:39], v[38:39], v[82:83], v[82:83] op_sel:[0,0,1] op_sel_hi:[1,0,1]
    v_pk_fma_f32 v[40:41], v[40:41], v[82:83], v[82:83] op_sel:[0,0,1] op_sel_hi:[1,0,1]
    v_pk_fma_f32 v[42:43], v[42:43], v[82:83], v[82:83] op_sel:[0,0,1] op_sel_hi:[1,0,1]
    v_pk_fma_f32 v[44:45], v[44:45], v[82:83], v[82:83] op_sel:[0,0,1] op_sel_hi:[1,0,1]
    v_pk_fma_f32 v[46:47], v[46:47], v[82:83], v[82:83] op_sel:[0,0,1] op_sel_hi:[1,0,1]
    v_pk_fma_f32 v[32:33], v[32:33], v[176:177], v[160:161]
    v_pk_fma_f32 v[34:35], v[34:35], v[178:179], v[162:163]
    v_pk_fma_f32 v[36:37], v[36:37], v[180:181], v[164:165]
    v_pk_fma_f32 v[38:39], v[38:39], v[182:183], v[166:167]
    v_pk_fma_f32 v[40:41], v[40:41], v[184:185], v[168:169]
    v_pk_fma_f32 v[42:43], v[42:43], v[186:187], v[170:171]
    v_pk_fma_f32 v[44:45], v[44:45], v[188:189], v[172:173]
    v_pk_fma_f32 v[46:47], v[46:47], v[190:191], v[174:175]
    v_cvt_pk_bf16_f32 v48, v32, v33
    v_cvt_pk_bf16_f32 v49, v34, v35
    v_cvt_pk_bf16_f32 v50, v36, v37
    v_cvt_pk_bf16_f32 v51, v38, v39
    v_cvt_pk_bf16_f32 v52, v40, v41
    v_cvt_pk_bf16_f32 v53, v42, v43
    v_cvt_pk_bf16_f32 v54, v44, v45
    v_cvt_pk_bf16_f32 v55, v46, v47
    buffer_store_dwordx4 v[48:51], v1, s[12:15], s81 offen sc1
    buffer_store_dwordx4 v[52:55], v1, s[12:15], s81 offen offset:1024 sc1
    v_mov_b32 v3, s96
    v_mov_b32 v2, 0
    s_waitcnt vmcnt(0)
    s_cmp_eq_u32 s97, 0
    s_cbranch_scc1 L_sigg_16
    s_mov_b64 exec, 1
    buffer_store_dword v3, v2, s[12:15], s95 offen
    s_mov_b64 exec, -1
    s_branch L_sigd_17
L_sigg_16:
    s_barrier
    s_cmp_lg_u32 s3, 0
    s_cbranch_scc1 L_sigd_17
    v_lshlrev_b32 v2, 2, v0
    s_mov_b64 exec, 15
    buffer_store_dword v3, v2, s[12:15], s95 offen sc1
    s_mov_b64 exec, -1
L_sigd_17:
    s_mul_i32 s68, s3, 12288
    s_add_u32 s68, s68, 57344
    v_add_u32 v216, s68, v242
    v_add_u32 v217, s68, v243
    s_mul_i32 s69, s3, 12288
    s_add_u32 s69, s69, 0
    v_add_u32 v218, s69, v242
    v_add_u32 v219, s69, v243
    s_mul_i32 s70, s3, 12288
    s_add_u32 s70, s70, 106496
    v_add_u32 v220, s70, v242
    v_add_u32 v221, s70, v243
    s_mul_i32 s66, s3, 458752
    s_lshl_b32 s24, s5, 7
    s_add_u32 s66, s66, s24
    s_mov_b32 s16, s48
    s_mov_b32 s17, s49
    s_mov_b32 s18, 1835008
    s_mov_b32 s19, 0x20000
    s_mov_b32 s101, 0
L_spin_18:
    buffer_load_dword v3, v5, s[12:15], s88 offen sc1
    s_waitcnt vmcnt(0)
    v_cmp_eq_u32 vcc, s96, v3
    s_nop 0
    s_cmp_eq_u64 vcc, exec
    s_cbranch_scc1 L_spun_19
    s_add_u32 s101, s101, 1
    s_cmp_lt_u32 s101, 1048576
    s_cbranch_scc1 L_spin_18
L_spun_19:
    s_lshl_b32 s62, s6, 15
    s_add_u32 s62, s62, 3145728
    buffer_load_dwordx4 a[128:131], v1, s[12:15], s62 offen offset:0 sc1
    buffer_load_dwordx4 a[132:135], v1, s[12:15], s62 offen offset:1024 sc1
    buffer_load_dwordx4 a[136:139], v1, s[12:15], s62 offen offset:2048 sc1
    buffer_load_dwordx4 a[140:143], v1, s[12:15], s62 offen offset:3072 sc1
    s_add_u32 s62, s62, 4096
    buffer_load_dwordx4 a[144:147], v1, s[12:15], s62 offen offset:0 sc1
    buffer_load_dwordx4 a[148:151], v1, s[12:15], s62 offen offset:1024 sc1
    s_barrier
    ds_read_b64_tr_b16 v[160:161], v239 offset:0
    ds_read_b64_tr_b16 v[162:163], v239 offset:1792
    ds_read_b64_tr_b16 v[164:165], v239 offset:32
    ds_read_b64_tr_b16 v[166:167], v239 offset:1824
    ds_read_b64_tr_b16 v[168:169], v239 offset:64
    ds_read_b64_tr_b16 v[170:171], v239 offset:1856
    ds_read_b64_tr_b16 v[172:173], v239 offset:96
    ds_read_b64_tr_b16 v[174:175], v239 offset:1888
    ds_read_b64_tr_b16 v[176:177], v239 offset:128
    ds_read_b64_tr_b16 v[178:179], v239 offset:1920
    ds_read_b64_tr_b16 v[180:181], v239 offset:160
    ds_read_b64_tr_b16 v[182:183], v239 offset:1952
    ds_read_b64_tr_b16 v[184:185], v239 offset:192
    ds_read_b64_tr_b16 v[186:187], v239 offset:1984
    s_waitcnt vmcnt(5) lgkmcnt(12)
    v_mfma_f32_32x32x16_bf16 v[16:31], v[160:163], a[128:131], 0
    s_waitcnt lgkmcnt(10)
    v_mfma_f32_32x32x16_bf16 v[32:47], v[164:167], a[128:131], 0
    buffer_load_dwordx4 a[152:155], v1, s[12:15], s62 offen offset:2048 sc1
    ds_read_b64_tr_b16 v[188:189], v239 offset:3584
    ds_read_b64_tr_b16 v[190:191], v239 offset:5376
    s_waitcnt lgkmcnt(10)
    v_mfma_f32_32x32x16_bf16 v[48:63], v[168:171], a[128:131], 0
    ds_read_b64_tr_b16 v[192:193], v239 offset:3616
    ds_read_b64_tr_b16 v[194:195], v239 offset:5408
    ds_read_b64_tr_b16 v[196:197], v239 offset:3648
    s_waitcnt lgkmcnt(11)
    v_mfma_f32_32x32x16_bf16 v[64:79], v[172:175], a[128:131], 0
    buffer_load_dwordx4 a[156:159], v1, s[12:15], s62 offen offset:3072 sc1
    ds_read_b64_tr_b16 v[198:199], v239 offset:5440
    ds_read_b64_tr_b16 v[200:201], v239 offset:3680
    s_waitcnt lgkmcnt(11)
    v_mfma_f32_32x32x16_bf16 v[80:95], v[176:179], a[128:131], 0
    ds_read_b64_tr_b16 v[202:203], v239 offset:5472
    ds_read_b64_tr_b16 v[204:205], v239 offset:3712
    ds_read_b64_tr_b16 v[206:207], v239 offset:5504
    s_waitcnt lgkmcnt(12)
    v_mfma_f32_32x32x16_bf16 v[96:111], v[180:183], a[128:131], 0
    s_add_u32 s62, s62, 4096
    ds_read_b64_tr_b16 v[208:209], v239 offset:3744
    ds_read_b64_tr_b16 v[210:211], v239 offset:5536
    s_waitcnt lgkmcnt(12)
    v_mfma_f32_32x32x16_bf16 v[112:127], v[184:187], a[128:131], 0
    ds_read_b64_tr_b16 v[212:213], v239 offset:3776
    ds_read_b64_tr_b16 v[214:215], v239 offset:5568
    s_waitcnt vmcnt(6) lgkmcnt(12)
    v_mfma_f32_32x32x16_bf16 v[16:31], v[188:191], a[132:135], v[16:31]
    s_waitcnt lgkmcnt(10)
    v_mfma_f32_32x32x16_bf16 v[32:47], v[192:195], a[132:135], v[32:47]
    buffer_load_dwordx4 a[160:163], v1, s[12:15], s62 offen offset:0 sc1
    ds_read_b64_tr_b16 v[160:161], v239 offset:14336
    ds_read_b64_tr_b16 v[162:163], v239 offset:16128
    s_waitcnt lgkmcnt(10)
    v_mfma_f32_32x32x16_bf16 v[48:63], v[196:199], a[132:135], v[48:63]
    ds_read_b64_tr_b16 v[164:165], v239 offset:14368
    ds_read_b64_tr_b16 v[166:167], v239 offset:16160
    ds_read_b64_tr_b16 v[168:169], v239 offset:14400
    s_waitcnt lgkmcnt(11)
    v_mfma_f32_32x32x16_bf16 v[64:79], v[200:203], a[132:135], v[64:79]
    ds_read_b64_tr_b16 v[170:171], v239 offset:16192
    ds_read_b64_tr_b16 v[172:173], v239 offset:14432
    s_waitcnt lgkmcnt(11)
    v_mfma_f32_32x32x16_bf16 v[80:95], v[204:207], a[132:135], v[80:95]
    buffer_load_dwordx4 a[164:167], v1, s[12:15], s62 offen offset:1024 sc1
    ds_read_b64_tr_b16 v[174:175], v239 offset:16224
    ds_read_b64_tr_b16 v[176:177], v239 offset:14464
    s_waitcnt lgkmcnt(11)
    v_mfma_f32_32x32x16_bf16 v[96:111], v[208:211], a[132:135], v[96:111]
    ds_read_b64_tr_b16 v[178:179], v239 offset:16256
    ds_read_b64_tr_b16 v[180:181], v239 offset:14496
    ds_read_b64_tr_b16 v[182:183], v239 offset:16288
    s_waitcnt lgkmcnt(12)
    v_mfma_f32_32x32x16_bf16 v[112:127], v[212:215], a[132:135], v[112:127]
    ds_read_b64_tr_b16 v[184:185], v239 offset:14528
    ds_read_b64_tr_b16 v[186:187], v239 offset:16320
    s_waitcnt vmcnt(7) lgkmcnt(12)
    v_mfma_f32_32x32x16_bf16 v[16:31], v[160:163], a[136:139], v[16:31]
    s_waitcnt lgkmcnt(10)
    v_mfma_f32_32x32x16_bf16 v[32:47], v[164:167], a[136:139], v[32:47]
    buffer_load_dwordx4 a[168:171], v1, s[12:15], s62 offen offset:2048 sc1
    ds_read_b64_tr_b16 v[188:189], v239 offset:17920
    ds_read_b64_tr_b16 v[190:191], v239 offset:19712
    s_waitcnt lgkmcnt(10)
    v_mfma_f32_32x32x16_bf16 v[48:63], v[168:171], a[136:139], v[48:63]
    ds_read_b64_tr_b16 v[192:193], v239 offset:17952
    ds_read_b64_tr_b16 v[194:195], v239 offset:19744
    ds_read_b64_tr_b16 v[196:197], v239 offset:17984
    s_waitcnt lgkmcnt(11)
    v_mfma_f32_32x32x16_bf16 v[64:79], v[172:175], a[136:139], v[64:79]
    buffer_load_dwordx4 a[172:175], v1, s[12:15], s62 offen offset:3072 sc1
    ds_read_b64_tr_b16 v[198:199], v239 offset:19776
    ds_read_b64_tr_b16 v[200:201], v239 offset:18016
    s_waitcnt lgkmcnt(11)
    v_mfma_f32_32x32x16_bf16 v[80:95], v[176:179], a[136:139], v[80:95]
    ds_read_b64_tr_b16 v[202:203], v239 offset:19808
    ds_read_b64_tr_b16 v[204:205], v239 offset:18048
    ds_read_b64_tr_b16 v[206:207], v239 offset:19840
    s_waitcnt lgkmcnt(12)
    v_mfma_f32_32x32x16_bf16 v[96:111], v[180:183], a[136:139], v[96:111]
    s_add_u32 s62, s62, 4096
    ds_read_b64_tr_b16 v[208:209], v239 offset:18080
    ds_read_b64_tr_b16 v[210:211], v239 offset:19872
    s_waitcnt lgkmcnt(12)
    v_mfma_f32_32x32x16_bf16 v[112:127], v[184:187], a[136:139], v[112:127]
    ds_read_b64_tr_b16 v[212:213], v239 offset:18112
    ds_read_b64_tr_b16 v[214:215], v239 offset:19904
    s_waitcnt vmcnt(8) lgkmcnt(12)
    v_mfma_f32_32x32x16_bf16 v[16:31], v[188:191], a[140:143], v[16:31]
    s_waitcnt lgkmcnt(0)
    s_barrier
    v_mfma_f32_32x32x16_bf16 v[32:47], v[192:195], a[140:143], v[32:47]
    buffer_load_dwordx4 a[176:179], v1, s[12:15], s62 offen offset:0 sc1
    ds_read_b64_tr_b16 v[160:161], v239 offset:28672
    ds_read_b64_tr_b16 v[162:163], v239 offset:30464
    v_mfma_f32_32x32x16_bf16 v[48:63], v[196:199], a[140:143], v[48:63]
    ds_read_b64_tr_b16 v[164:165], v239 offset:28704
    ds_read_b64_tr_b16 v[166:167], v239 offset:30496
    ds_read_b64_tr_b16 v[168:169], v239 offset:28736
    v_mfma_f32_32x32x16_bf16 v[64:79], v[200:203], a[140:143], v[64:79]
    ds_read_b64_tr_b16 v[170:171], v239 offset:30528
    ds_read_b64_tr_b16 v[172:173], v239 offset:28768
    v_mfma_f32_32x32x16_bf16 v[80:95], v[204:207], a[140:143], v[80:95]
    buffer_load_dwordx4 a[180:183], v1, s[12:15], s62 offen offset:1024 sc1
    ds_read_b64_tr_b16 v[174:175], v239 offset:30560
    ds_read_b64_tr_b16 v[176:177], v239 offset:28800
    v_mfma_f32_32x32x16_bf16 v[96:111], v[208:211], a[140:143], v[96:111]
    ds_read_b64_tr_b16 v[178:179], v239 offset:30592
    ds_read_b64_tr_b16 v[180:181], v239 offset:28832
    ds_read_b64_tr_b16 v[182:183], v239 offset:30624
    v_mfma_f32_32x32x16_bf16 v[112:127], v[212:215], a[140:143], v[112:127]
    ds_read_b64_tr_b16 v[184:185], v239 offset:28864
    ds_read_b64_tr_b16 v[186:187], v239 offset:30656
    s_waitcnt vmcnt(9) lgkmcnt(12)
    v_mfma_f32_32x32x16_bf16 v[16:31], v[160:163], a[144:147], v[16:31]
    s_waitcnt lgkmcnt(10)
    v_mfma_f32_32x32x16_bf16 v[32:47], v[164:167], a[144:147], v[32:47]
    buffer_load_dwordx4 a[184:187], v1, s[12:15], s62 offen offset:2048 sc1
    ds_read_b64_tr_b16 v[188:189], v239 offset:32256
    ds_read_b64_tr_b16 v[190:191], v239 offset:34048
    buffer_load_dwordx4 a[188:191], v1, s[12:15], s62 offen offset:3072 sc1
    s_waitcnt lgkmcnt(10)
    v_mfma_f32_32x32x16_bf16 v[48:63], v[168:171], a[144:147], v[48:63]
    ds_read_b64_tr_b16 v[192:193], v239 offset:32288
    ds_read_b64_tr_b16 v[194:195], v239 offset:34080
    s_add_u32 s62, s62, 4096
    ds_read_b64_tr_b16 v[196:197], v239 offset:32320
    s_waitcnt lgkmcnt(11)
    v_mfma_f32_32x32x16_bf16 v[64:79], v[172:175], a[144:147], v[64:79]
    ds_read_b64_tr_b16 v[198:199], v239 offset:34112
    s_add_u32 s63, s60, 917504
    ds_read_b64_tr_b16 v[200:201], v239 offset:32352
    s_waitcnt lgkmcnt(11)
    v_mfma_f32_32x32x16_bf16 v[80:95], v[176:179], a[144:147], v[80:95]
    s_add_u32 m0, s61, 106496
    ds_read_b64_tr_b16 v[202:203], v239 offset:34144
    ds_read_b64_tr_b16 v[204:205], v239 offset:32384
    buffer_load_dwordx4 v232, s[20:23], s63 offen lds
    s_waitcnt lgkmcnt(11)
    v_mfma_f32_32x32x16_bf16 v[96:111], v[180:183], a[144:147], v[96:111]
    ds_read_b64_tr_b16 v[206:207], v239 offset:34176
    ds_read_b64_tr_b16 v[208:209], v239 offset:32416
    s_add_u32 m0, s61, 107520
    ds_read_b64_tr_b16 v[210:211], v239 offset:34208
    s_waitcnt lgkmcnt(12)
    v_mfma_f32_32x32x16_bf16 v[112:127], v[184:187], a[144:147], v[112:127]
    ds_read_b64_tr_b16 v[212:213], v239 offset:32448
    buffer_load_dwordx4 v233, s[20:23], s63 offen lds
    ds_read_b64_tr_b16 v[214:215], v239 offset:34240
    s_waitcnt vmcnt(12) lgkmcnt(12)
    v_mfma_f32_32x32x16_bf16 v[16:31], v[188:191], a[148:151], v[16:31]
    s_waitcnt lgkmcnt(10)
    v_mfma_f32_32x32x16_bf16 v[32:47], v[192:195], a[148:151], v[32:47]
    buffer_load_dwordx4 a[192:195], v1, s[12:15], s62 offen offset:0 sc1
    ds_read_b64_tr_b16 v[160:161], v239 offset:43008
    ds_read_b64_tr_b16 v[162:163], v239 offset:44800
    ds_read_b64_tr_b16 v[164:165], v239 offset:43040
    s_waitcnt lgkmcnt(11)
    v_mfma_f32_32x32x16_bf16 v[48:63], v[196:199], a[148:151], v[48:63]
    buffer_load_dwordx4 a[196:199], v1, s[12:15], s62 offen offset:1024 sc1
    ds_read_b64_tr_b16 v[166:167], v239 offset:44832
    ds_read_b64_tr_b16 v[168:169], v239 offset:43072
    s_waitcnt lgkmcnt(11)
    v_mfma_f32_32x32x16_bf16 v[64:79], v[200:203], a[148:151], v[64:79]
    s_add_u32 m0, s61, 108544
    ds_read_b64_tr_b16 v[170:171], v239 offset:44864
    ds_read_b64_tr_b16 v[172:173], v239 offset:43104
    s_waitcnt lgkmcnt(11)
    v_mfma_f32_32x32x16_bf16 v[80:95], v[204:207], a[148:151], v[80:95]
    buffer_load_dwordx4 v234, s[20:23], s63 offen lds
    ds_read_b64_tr_b16 v[174:175], v239 offset:44896
    ds_read_b64_tr_b16 v[176:177], v239 offset:43136
    ds_read_b64_tr_b16 v[178:179], v239 offset:44928
    s_waitcnt lgkmcnt(12)
    v_mfma_f32_32x32x16_bf16 v[96:111], v[208:211], a[148:151], v[96:111]
    s_add_u32 m0, s61, 109568
    ds_read_b64_tr_b16 v[180:181], v239 offset:43168
    ds_read_b64_tr_b16 v[182:183], v239 offset:44960
    s_waitcnt lgkmcnt(12)
    v_mfma_f32_32x32x16_bf16 v[112:127], v[212:215], a[148:151], v[112:127]
    buffer_load_dwordx4 v235, s[20:23], s63 offen lds
    ds_read_b64_tr_b16 v[184:185], v239 offset:43200
    ds_read_b64_tr_b16 v[186:187], v239 offset:44992
    s_waitcnt vmcnt(15) lgkmcnt(12)
    v_mfma_f32_32x32x16_bf16 v[16:31], v[160:163], a[152:155], v[16:31]
    s_waitcnt lgkmcnt(10)
    v_mfma_f32_32x32x16_bf16 v[32:47], v[164:167], a[152:155], v[32:47]
    buffer_load_dwordx4 a[200:203], v1, s[12:15], s62 offen offset:2048 sc1
    ds_read_b64_tr_b16 v[188:189], v239 offset:46592
    ds_read_b64_tr_b16 v[190:191], v239 offset:48384
    buffer_load_dwordx4 a[204:207], v1, s[12:15], s62 offen offset:3072 sc1
    s_waitcnt lgkmcnt(10)
    v_mfma_f32_32x32x16_bf16 v[48:63], v[168:171], a[152:155], v[48:63]
    ds_read_b64_tr_b16 v[192:193], v239 offset:46624
    ds_read_b64_tr_b16 v[194:195], v239 offset:48416
    s_add_u32 s62, s62, 4096
    s_waitcnt lgkmcnt(10)
    v_mfma_f32_32x32x16_bf16 v[64:79], v[172:175], a[152:155], v[64:79]
    ds_read_b64_tr_b16 v[196:197], v239 offset:46656
    ds_read_b64_tr_b16 v[198:199], v239 offset:48448
    s_add_u32 m0, s61, 110592
    ds_read_b64_tr_b16 v[200:201], v239 offset:46688
    s_waitcnt lgkmcnt(11)
    v_mfma_f32_32x32x16_bf16 v[80:95], v[176:179], a[152:155], v[80:95]
    ds_read_b64_tr_b16 v[202:203], v239 offset:48480
    buffer_load_dwordx4 v236, s[20:23], s63 offen lds
    ds_read_b64_tr_b16 v[204:205], v239 offset:46720
    s_waitcnt lgkmcnt(11)
    v_mfma_f32_32x32x16_bf16 v[96:111], v[180:183], a[152:155], v[96:111]
    ds_read_b64_tr_b16 v[206:207], v239 offset:48512
    s_add_u32 m0, s61, 111616
    ds_read_b64_tr_b16 v[208:209], v239 offset:46752
    ds_read_b64_tr_b16 v[210:211], v239 offset:48544
    s_waitcnt lgkmcnt(12)
    v_mfma_f32_32x32x16_bf16 v[112:127], v[184:187], a[152:155], v[112:127]
    buffer_load_dwordx4 v237, s[20:23], s63 offen lds
    ds_read_b64_tr_b16 v[212:213], v239 offset:46784
    ds_read_b64_tr_b16 v[214:215], v239 offset:48576
    s_waitcnt vmcnt(18) lgkmcnt(12)
    v_mfma_f32_32x32x16_bf16 v[16:31], v[188:191], a[156:159], v[16:31]
    s_waitcnt lgkmcnt(0)
    s_barrier
    v_mfma_f32_32x32x16_bf16 v[32:47], v[192:195], a[156:159], v[32:47]
    buffer_load_dwordx4 a[208:211], v1, s[12:15], s62 offen offset:0 sc1
    ds_read_b64_tr_b16 v[160:161], v240 offset:0
    ds_read_b64_tr_b16 v[162:163], v240 offset:1792
    v_mfma_f32_32x32x16_bf16 v[48:63], v[196:199], a[156:159], v[48:63]
    ds_read_b64_tr_b16 v[164:165], v240 offset:32
    ds_read_b64_tr_b16 v[166:167], v240 offset:1824
    buffer_load_dwordx4 a[212:215], v1, s[12:15], s62 offen offset:1024 sc1
    v_mfma_f32_32x32x16_bf16 v[64:79], v[200:203], a[156:159], v[64:79]
    ds_read_b64_tr_b16 v[168:169], v240 offset:64
    ds_read_b64_tr_b16 v[170:171], v240 offset:1856
    ds_read_b64_tr_b16 v[172:173], v240 offset:96
    v_mfma_f32_32x32x16_bf16 v[80:95], v[204:207], a[156:159], v[80:95]
    s_add_u32 m0, s61, 112640
    ds_read_b64_tr_b16 v[174:175], v240 offset:1888
    ds_read_b64_tr_b16 v[176:177], v240 offset:128
    v_mfma_f32_32x32x16_bf16 v[96:111], v[208:211], a[156:159], v[96:111]
    ds_read_b64_tr_b16 v[178:179], v240 offset:1920
    ds_read_b64_tr_b16 v[180:181], v240 offset:160
    buffer_load_dwordx4 v238, s[20:23], s63 offen lds
    v_mfma_f32_32x32x16_bf16 v[112:127], v[212:215], a[156:159], v[112:127]
    ds_read_b64_tr_b16 v[182:183], v240 offset:1952
    ds_read_b64_tr_b16 v[184:185], v240 offset:192
    ds_read_b64_tr_b16 v[186:187], v240 offset:1984
    s_waitcnt vmcnt(20) lgkmcnt(12)
    v_mfma_f32_32x32x16_bf16 v[16:31], v[160:163], a[160:163], v[16:31]
    s_waitcnt lgkmcnt(10)
    v_mfma_f32_32x32x16_bf16 v[32:47], v[164:167], a[160:163], v[32:47]
    buffer_load_dwordx4 a[216:219], v1, s[12:15], s62 offen offset:2048 sc1
    ds_read_b64_tr_b16 v[188:189], v240 offset:3584
    ds_read_b64_tr_b16 v[190:191], v240 offset:5376
    buffer_load_dwordx4 a[220:223], v1, s[12:15], s62 offen offset:3072 sc1
    s_waitcnt lgkmcnt(10)
    v_mfma_f32_32x32x16_bf16 v[48:63], v[168:171], a[160:163], v[48:63]
    ds_read_b64_tr_b16 v[192:193], v240 offset:3616
    ds_read_b64_tr_b16 v[194:195], v240 offset:5408
    s_add_u32 s62, s62, 4096
    ds_read_b64_tr_b16 v[196:197], v240 offset:3648
    s_waitcnt lgkmcnt(11)
    v_mfma_f32_32x32x16_bf16 v[64:79], v[172:175], a[160:163], v[64:79]
    ds_read_b64_tr_b16 v[198:199], v240 offset:5440
    s_add_u32 s63, s60, 1146880
    ds_read_b64_tr_b16 v[200:201], v240 offset:3680
    s_waitcnt lgkmcnt(11)
    v_mfma_f32_32x32x16_bf16 v[80:95], v[176:179], a[160:163], v[80:95]
    s_add_u32 m0, s61, 135168
    ds_read_b64_tr_b16 v[202:203], v240 offset:5472
    ds_read_b64_tr_b16 v[204:205], v240 offset:3712
    buffer_load_dwordx4 v232, s[20:23], s63 offen lds
    s_waitcnt lgkmcnt(11)
    v_mfma_f32_32x32x16_bf16 v[96:111], v[180:183], a[160:163], v[96:111]
    ds_read_b64_tr_b16 v[206:207], v240 offset:5504
    ds_read_b64_tr_b16 v[208:209], v240 offset:3744
    s_add_u32 m0, s61, 136192
    ds_read_b64_tr_b16 v[210:211], v240 offset:5536
    s_waitcnt lgkmcnt(12)
    v_mfma_f32_32x32x16_bf16 v[112:127], v[184:187], a[160:163], v[112:127]
    ds_read_b64_tr_b16 v[212:213], v240 offset:3776
    buffer_load_dwordx4 v233, s[20:23], s63 offen lds
    ds_read_b64_tr_b16 v[214:215], v240 offset:5568
    s_waitcnt vmcnt(23) lgkmcnt(12)
    v_mfma_f32_32x32x16_bf16 v[16:31], v[188:191], a[164:167], v[16:31]
    s_waitcnt lgkmcnt(10)
    v_mfma_f32_32x32x16_bf16 v[32:47], v[192:195], a[164:167], v[32:47]
    buffer_load_dwordx4 a[224:227], v1, s[12:15], s62 offen offset:0 sc1
    ds_read_b64_tr_b16 v[160:161], v240 offset:14336
    ds_read_b64_tr_b16 v[162:163], v240 offset:16128
    ds_read_b64_tr_b16 v[164:165], v240 offset:14368
    s_waitcnt lgkmcnt(11)
    v_mfma_f32_32x32x16_bf16 v[48:63], v[196:199], a[164:167], v[48:63]
    buffer_load_dwordx4 a[228:231], v1, s[12:15], s62 offen offset:1024 sc1
    ds_read_b64_tr_b16 v[166:167], v240 offset:16160
    ds_read_b64_tr_b16 v[168:169], v240 offset:14400
    s_waitcnt lgkmcnt(11)
    v_mfma_f32_32x32x16_bf16 v[64:79], v[200:203], a[164:167], v[64:79]
    s_add_u32 m0, s61, 137216
    ds_read_b64_tr_b16 v[170:171], v240 offset:16192
    ds_read_b64_tr_b16 v[172:173], v240 offset:14432
    s_waitcnt lgkmcnt(11)
    v_mfma_f32_32x32x16_bf16 v[80:95], v[204:207], a[164:167], v[80:95]
    buffer_load_dwordx4 v234, s[20:23], s63 offen lds
    ds_read_b64_tr_b16 v[174:175], v240 offset:16224
    ds_read_b64_tr_b16 v[176:177], v240 offset:14464
    ds_read_b64_tr_b16 v[178:179], v240 offset:16256
    s_waitcnt lgkmcnt(12)
    v_mfma_f32_32x32x16_bf16 v[96:111], v[208:211], a[164:167], v[96:111]
    s_add_u32 m0, s61, 138240
    ds_read_b64_tr_b16 v[180:181], v240 offset:14496
    ds_read_b64_tr_b16 v[182:183], v240 offset:16288
    s_waitcnt lgkmcnt(12)
    v_mfma_f32_32x32x16_bf16 v[112:127], v[212:215], a[164:167], v[112:127]
    buffer_load_dwordx4 v235, s[20:23], s63 offen lds
    ds_read_b64_tr_b16 v[184:185], v240 offset:14528
    ds_read_b64_tr_b16 v[186:187], v240 offset:16320
    s_waitcnt vmcnt(26) lgkmcnt(12)
    v_mfma_f32_32x32x16_bf16 v[16:31], v[160:163], a[168:171], v[16:31]
    s_waitcnt lgkmcnt(10)
    v_mfma_f32_32x32x16_bf16 v[32:47], v[164:167], a[168:171], v[32:47]
    buffer_load_dwordx4 a[232:235], v1, s[12:15], s62 offen offset:2048 sc1
    ds_read_b64_tr_b16 v[188:189], v240 offset:17920
    ds_read_b64_tr_b16 v[190:191], v240 offset:19712
    buffer_load_dwordx4 a[236:239], v1, s[12:15], s62 offen offset:3072 sc1
    s_waitcnt lgkmcnt(10)
    v_mfma_f32_32x32x16_bf16 v[48:63], v[168:171], a[168:171], v[48:63]
    ds_read_b64_tr_b16 v[192:193], v240 offset:17952
    ds_read_b64_tr_b16 v[194:195], v240 offset:19744
    s_add_u32 s62, s62, 4096
    s_waitcnt lgkmcnt(10)
    v_mfma_f32_32x32x16_bf16 v[64:79], v[172:175], a[168:171], v[64:79]
    ds_read_b64_tr_b16 v[196:197], v240 offset:17984
    ds_read_b64_tr_b16 v[198:199], v240 offset:19776
    s_add_u32 m0, s61, 139264
    ds_read_b64_tr_b16 v[200:201], v240 offset:18016
    s_waitcnt lgkmcnt(11)
    v_mfma_f32_32x32x16_bf16 v[80:95], v[176:179], a[168:171], v[80:95]
    ds_read_b64_tr_b16 v[202:203], v240 offset:19808
    buffer_load_dwordx4 v236, s[20:23], s63 offen lds
    ds_read_b64_tr_b16 v[204:205], v240 offset:18048
    s_waitcnt lgkmcnt(11)
    v_mfma_f32_32x32x16_bf16 v[96:111], v[180:183], a[168:171], v[96:111]
    ds_read_b64_tr_b16 v[206:207], v240 offset:19840
    s_add_u32 m0, s61, 140288
    ds_read_b64_tr_b16 v[208:209], v240 offset:18080
    ds_read_b64_tr_b16 v[210:211], v240 offset:19872
    s_waitcnt lgkmcnt(12)
    v_mfma_f32_32x32x16_bf16 v[112:127], v[184:187], a[168:171], v[112:127]
    buffer_load_dwordx4 v237, s[20:23], s63 offen lds
    ds_read_b64_tr_b16 v[212:213], v240 offset:18112
    ds_read_b64_tr_b16 v[214:215], v240 offset:19904
    s_waitcnt vmcnt(29) lgkmcnt(12)
    v_mfma_f32_32x32x16_bf16 v[16:31], v[188:191], a[172:175], v[16:31]
    s_waitcnt lgkmcnt(0)
    s_barrier
    v_mfma_f32_32x32x16_bf16 v[32:47], v[192:195], a[172:175], v[32:47]
    buffer_load_dwordx4 a[240:243], v1, s[12:15], s62 offen offset:0 sc1
    ds_read_b64_tr_b16 v[160:161], v240 offset:28672
    ds_read_b64_tr_b16 v[162:163], v240 offset:30464
    v_mfma_f32_32x32x16_bf16 v[48:63], v[196:199], a[172:175], v[48:63]
    ds_read_b64_tr_b16 v[164:165], v240 offset:28704
    ds_read_b64_tr_b16 v[166:167], v240 offset:30496
    buffer_load_dwordx4 a[244:247], v1, s[12:15], s62 offen offset:1024 sc1
    v_mfma_f32_32x32x16_bf16 v[64:79], v[200:203], a[172:175], v[64:79]
    ds_read_b64_tr_b16 v[168:169], v240 offset:28736
    ds_read_b64_tr_b16 v[170:171], v240 offset:30528
    ds_read_b64_tr_b16 v[172:173], v240 offset:28768
    v_mfma_f32_32x32x16_bf16 v[80:95], v[204:207], a[172:175], v[80:95]
    s_add_u32 m0, s61, 141312
    ds_read_b64_tr_b16 v[174:175], v240 offset:30560
    ds_read_b64_tr_b16 v[176:177], v240 offset:28800
    v_mfma_f32_32x32x16_bf16 v[96:111], v[208:211], a[172:175], v[96:111]
    ds_read_b64_tr_b16 v[178:179], v240 offset:30592
    ds_read_b64_tr_b16 v[180:181], v240 offset:28832
    buffer_load_dwordx4 v238, s[20:23], s63 offen lds
    v_mfma_f32_32x32x16_bf16 v[112:127], v[212:215], a[172:175], v[112:127]
    ds_read_b64_tr_b16 v[182:183], v240 offset:30624
    ds_read_b64_tr_b16 v[184:185], v240 offset:28864
    ds_read_b64_tr_b16 v[186:187], v240 offset:30656
    s_waitcnt vmcnt(31) lgkmcnt(12)
    v_mfma_f32_32x32x16_bf16 v[16:31], v[160:163], a[176:179], v[16:31]
    s_waitcnt lgkmcnt(10)
    v_mfma_f32_32x32x16_bf16 v[32:47], v[164:167], a[176:179], v[32:47]
    buffer_load_dwordx4 a[248:251], v1, s[12:15], s62 offen offset:2048 sc1
    ds_read_b64_tr_b16 v[188:189], v240 offset:32256
    ds_read_b64_tr_b16 v[190:191], v240 offset:34048
    buffer_load_dwordx4 a[252:255], v1, s[12:15], s62 offen offset:3072 sc1
    s_waitcnt lgkmcnt(10)
    v_mfma_f32_32x32x16_bf16 v[48:63], v[168:171], a[176:179], v[48:63]
    ds_read_b64_tr_b16 v[192:193], v240 offset:32288
    ds_read_b64_tr_b16 v[194:195], v240 offset:34080
    s_add_u32 s62, s62, 4096
    ds_read_b64_tr_b16 v[196:197], v240 offset:32320
    s_waitcnt lgkmcnt(11)
    v_mfma_f32_32x32x16_bf16 v[64:79], v[172:175], a[176:179], v[64:79]
    ds_read_b64_tr_b16 v[198:199], v240 offset:34112
    s_add_u32 s63, s60, 1376256
    ds_read_b64_tr_b16 v[200:201], v240 offset:32352
    s_waitcnt lgkmcnt(11)
    v_mfma_f32_32x32x16_bf16 v[80:95], v[176:179], a[176:179], v[80:95]
    s_add_u32 m0, s61, 0
    ds_read_b64_tr_b16 v[202:203], v240 offset:34144
    ds_read_b64_tr_b16 v[204:205], v240 offset:32384
    buffer_load_dwordx4 v232, s[20:23], s63 offen lds
    s_waitcnt lgkmcnt(11)
    v_mfma_f32_32x32x16_bf16 v[96:111], v[180:183], a[176:179], v[96:111]
    ds_read_b64_tr_b16 v[206:207], v240 offset:34176
    ds_read_b64_tr_b16 v[208:209], v240 offset:32416
    s_add_u32 m0, s61, 1024
    ds_read_b64_tr_b16 v[210:211], v240 offset:34208
    s_waitcnt lgkmcnt(12)
    v_mfma_f32_32x32x16_bf16 v[112:127], v[184:187], a[176:179], v[112:127]
    ds_read_b64_tr_b16 v[212:213], v240 offset:32448
    buffer_load_dwordx4 v233, s[20:23], s63 offen lds
    ds_read_b64_tr_b16 v[214:215], v240 offset:34240
    s_waitcnt vmcnt(34) lgkmcnt(12)
    v_mfma_f32_32x32x16_bf16 v[16:31], v[188:191], a[180:183], v[16:31]
    s_waitcnt lgkmcnt(10)
    v_mfma_f32_32x32x16_bf16 v[32:47], v[192:195], a[180:183], v[32:47]
    s_add_u32 m0, s61, 2048
    ds_read_b64_tr_b16 v[160:161], v240 offset:43008
    ds_read_b64_tr_b16 v[162:163], v240 offset:44800
    s_waitcnt lgkmcnt(10)
    v_mfma_f32_32x32x16_bf16 v[48:63], v[196:199], a[180:183], v[48:63]
    ds_read_b64_tr_b16 v[164:165], v240 offset:43040
    ds_read_b64_tr_b16 v[166:167], v240 offset:44832
    buffer_load_dwordx4 v234, s[20:23], s63 offen lds
    s_waitcnt lgkmcnt(10)
    v_mfma_f32_32x32x16_bf16 v[64:79], v[200:203], a[180:183], v[64:79]
    ds_read_b64_tr_b16 v[168:169], v240 offset:43072
    ds_read_b64_tr_b16 v[170:171], v240 offset:44864
    ds_read_b64_tr_b16 v[172:173], v240 offset:43104
    s_waitcnt lgkmcnt(11)
    v_mfma_f32_32x32x16_bf16 v[80:95], v[204:207], a[180:183], v[80:95]
    s_add_u32 m0, s61, 3072
    ds_read_b64_tr_b16 v[174:175], v240 offset:44896
    ds_read_b64_tr_b16 v[176:177], v240 offset:43136
    s_waitcnt lgkmcnt(11)
    v_mfma_f32_32x32x16_bf16 v[96:111], v[208:211], a[180:183], v[96:111]
    ds_read_b64_tr_b16 v[178:179], v240 offset:44928
    ds_read_b64_tr_b16 v[180:181], v240 offset:43168
    buffer_load_dwordx4 v235, s[20:23], s63 offen lds
    s_waitcnt lgkmcnt(11)
    v_mfma_f32_32x32x16_bf16 v[112:127], v[212:215], a[180:183], v[112:127]
    ds_read_b64_tr_b16 v[182:183], v240 offset:44960
    ds_read_b64_tr_b16 v[184:185], v240 offset:43200
    ds_read_b64_tr_b16 v[186:187], v240 offset:44992
    s_waitcnt vmcnt(35) lgkmcnt(12)
    v_mfma_f32_32x32x16_bf16 v[16:31], v[160:163], a[184:187], v[16:31]
    s_waitcnt lgkmcnt(10)
    v_mfma_f32_32x32x16_bf16 v[32:47], v[164:167], a[184:187], v[32:47]
    s_add_u32 m0, s61, 4096
    ds_read_b64_tr_b16 v[188:189], v240 offset:46592
    buffer_load_dwordx4 v236, s[20:23], s63 offen lds
    ds_read_b64_tr_b16 v[190:191], v240 offset:48384
    s_add_u32 m0, s61, 5120
    s_waitcnt lgkmcnt(10)
    v_mfma_f32_32x32x16_bf16 v[48:63], v[168:171], a[184:187], v[48:63]
    ds_read_b64_tr_b16 v[192:193], v240 offset:46624
    buffer_load_dwordx4 v237, s[20:23], s63 offen lds
    ds_read_b64_tr_b16 v[194:195], v240 offset:48416
    s_add_u32 s28, s66, 0
    ds_read_b64_tr_b16 v[196:197], v240 offset:46656
    s_waitcnt lgkmcnt(11)
    v_mfma_f32_32x32x16_bf16 v[64:79], v[172:175], a[184:187], v[64:79]
    s_add_u32 m0, s68, 0
    ds_read_b64_tr_b16 v[198:199], v240 offset:48448
    buffer_load_dwordx4 v241, s[16:19], s28 offen lds
    ds_read_b64_tr_b16 v[200:201], v240 offset:46688
    s_add_u32 s28, s66, 8192
    s_waitcnt lgkmcnt(11)
    v_mfma_f32_32x32x16_bf16 v[80:95], v[176:179], a[184:187], v[80:95]
    s_add_u32 m0, s68, 1024
    ds_read_b64_tr_b16 v[202:203], v240 offset:48480
    buffer_load_dwordx4 v241, s[16:19], s28 offen lds
    ds_read_b64_tr_b16 v[204:205], v240 offset:46720
    s_add_u32 s28, s66, 16384
    s_waitcnt lgkmcnt(11)
    v_mfma_f32_32x32x16_bf16 v[96:111], v[180:183], a[184:187], v[96:111]
    ds_read_b64_tr_b16 v[206:207], v240 offset:48512
    s_add_u32 m0, s68, 2048
    ds_read_b64_tr_b16 v[208:209], v240 offset:46752
    buffer_load_dwordx4 v241, s[16:19], s28 offen lds
    ds_read_b64_tr_b16 v[210:211], v240 offset:48544
    s_waitcnt lgkmcnt(12)
    v_mfma_f32_32x32x16_bf16 v[112:127], v[184:187], a[184:187], v[112:127]
    s_add_u32 s28, s66, 24576
    ds_read_b64_tr_b16 v[212:213], v240 offset:46784
    s_add_u32 m0, s68, 3072
    ds_read_b64_tr_b16 v[214:215], v240 offset:48576
    buffer_load_dwordx4 v241, s[16:19], s28 offen lds
    s_waitcnt vmcnt(40) lgkmcnt(12)
    v_mfma_f32_32x32x16_bf16 v[16:31], v[188:191], a[188:191], v[16:31]
    s_waitcnt vmcnt(27)
    s_waitcnt lgkmcnt(0)
    s_barrier
    v_mfma_f32_32x32x16_bf16 v[32:47], v[192:195], a[188:191], v[32:47]
    s_add_u32 m0, s61, 6144
    ds_read_b64_tr_b16 v[160:161], v239 offset:0
    ds_read_b64_tr_b16 v[162:163], v239 offset:1792
    v_mfma_f32_32x32x16_bf16 v[48:63], v[196:199], a[188:191], v[48:63]
    ds_read_b64_tr_b16 v[164:165], v239 offset:32
    ds_read_b64_tr_b16 v[166:167], v239 offset:1824
    ds_read_b64_tr_b16 v[168:169], v239 offset:64
    v_mfma_f32_32x32x16_bf16 v[64:79], v[200:203], a[188:191], v[64:79]
    ds_read_b64_tr_b16 v[170:171], v239 offset:1856
    ds_read_b64_tr_b16 v[172:173], v239 offset:96
    v_mfma_f32_32x32x16_bf16 v[80:95], v[204:207], a[188:191], v[80:95]
    buffer_load_dwordx4 v238, s[20:23], s63 offen lds
    ds_read_b64_tr_b16 v[174:175], v239 offset:1888
    ds_read_b64_tr_b16 v[176:177], v239 offset:128
    v_mfma_f32_32x32x16_bf16 v[96:111], v[208:211], a[188:191], v[96:111]
    ds_read_b64_tr_b16 v[178:179], v239 offset:1920
    ds_read_b64_tr_b16 v[180:181], v239 offset:160
    ds_read_b64_tr_b16 v[182:183], v239 offset:1952
    v_mfma_f32_32x32x16_bf16 v[112:127], v[212:215], a[188:191], v[112:127]
    ds_read_b64_tr_b16 v[184:185], v239 offset:192
    ds_read_b64_tr_b16 v[186:187], v239 offset:1984
    s_waitcnt lgkmcnt(12)
    v_mfma_f32_32x32x16_bf16 v[16:31], v[160:163], a[192:195], v[16:31]
    s_waitcnt lgkmcnt(10)
    v_mfma_f32_32x32x16_bf16 v[32:47], v[164:167], a[192:195], v[32:47]
    s_add_u32 s63, s60, 1605632
    ds_read_b64_tr_b16 v[188:189], v239 offset:3584
    s_add_u32 m0, s61, 28672
    ds_read_b64_tr_b16 v[190:191], v239 offset:5376
    buffer_load_dwordx4 v232, s[20:23], s63 offen lds
    ds_read_b64_tr_b16 v[192:193], v239 offset:3616
    s_waitcnt lgkmcnt(11)
    v_mfma_f32_32x32x16_bf16 v[48:63], v[168:171], a[192:195], v[48:63]
    s_add_u32 m0, s61, 29696
    ds_read_b64_tr_b16 v[194:195], v239 offset:5408
    buffer_load_dwordx4 v233, s[20:23], s63 offen lds
    ds_read_b64_tr_b16 v[196:197], v239 offset:3648
    s_add_u32 s28, s66, 32768
    s_waitcnt lgkmcnt(11)
    v_mfma_f32_32x32x16_bf16 v[64:79], v[172:175], a[192:195], v[64:79]
    s_add_u32 m0, s68, 4096
    ds_read_b64_tr_b16 v[198:199], v239 offset:5440
    buffer_load_dwordx4 v241, s[16:19], s28 offen lds
    ds_read_b64_tr_b16 v[200:201], v239 offset:3680
    s_add_u32 s28, s66, 40960
    s_waitcnt lgkmcnt(11)
    v_mfma_f32_32x32x16_bf16 v[80:95], v[176:179], a[192:195], v[80:95]
    ds_read_b64_tr_b16 v[202:203], v239 offset:5472
    s_add_u32 m0, s68, 5120
    ds_read_b64_tr_b16 v[204:205], v239 offset:3712
    buffer_load_dwordx4 v241, s[16:19], s28 offen lds
    ds_read_b64_tr_b16 v[206:207], v239 offset:5504
    s_waitcnt lgkmcnt(12)
    v_mfma_f32_32x32x16_bf16 v[96:111], v[180:183], a[192:195], v[96:111]
    s_add_u32 s28, s66, 49152
    s_add_u32 m0, s68, 6144
    ds_read_b64_tr_b16 v[208:209], v239 offset:3744
    buffer_load_dwordx4 v241, s[16:19], s28 offen lds
    ds_read_b64_tr_b16 v[210:211], v239 offset:5536
    s_waitcnt lgkmcnt(12)
    v_mfma_f32_32x32x16_bf16 v[112:127], v[184:187], a[192:195], v[112:127]
    s_add_u32 s28, s66, 57344
    ds_read_b64_tr_b16 v[212:213], v239 offset:3776
    s_add_u32 m0, s68, 7168
    ds_read_b64_tr_b16 v[214:215], v239 offset:5568
    buffer_load_dwordx4 v241, s[16:19], s28 offen lds
    s_waitcnt lgkmcnt(12)
    v_mfma_f32_32x32x16_bf16 v[16:31], v[188:191], a[196:199], v[16:31]
    s_waitcnt lgkmcnt(10)
    v_mfma_f32_32x32x16_bf16 v[32:47], v[192:195], a[196:199], v[32:47]
    s_add_u32 m0, s61, 30720
    ds_read_b64_tr_b16 v[160:161], v239 offset:14336
    ds_read_b64_tr_b16 v[162:163], v239 offset:16128
    s_waitcnt lgkmcnt(10)
    v_mfma_f32_32x32x16_bf16 v[48:63], v[196:199], a[196:199], v[48:63]
    ds_read_b64_tr_b16 v[164:165], v239 offset:14368
    ds_read_b64_tr_b16 v[166:167], v239 offset:16160
    buffer_load_dwordx4 v234, s[20:23], s63 offen lds
    s_waitcnt lgkmcnt(10)
    v_mfma_f32_32x32x16_bf16 v[64:79], v[200:203], a[196:199], v[64:79]
    ds_read_b64_tr_b16 v[168:169], v239 offset:14400
    ds_read_b64_tr_b16 v[170:171], v239 offset:16192
    ds_read_b64_tr_b16 v[172:173], v239 offset:14432
    s_waitcnt lgkmcnt(11)
    v_mfma_f32_32x32x16_bf16 v[80:95], v[204:207], a[196:199], v[80:95]
    s_add_u32 m0, s61, 31744
    ds_read_b64_tr_b16 v[174:175], v239 offset:16224
    ds_read_b64_tr_b16 v[176:177], v239 offset:14464
    s_waitcnt lgkmcnt(11)
    v_mfma_f32_32x32x16_bf16 v[96:111], v[208:211], a[196:199], v[96:111]
    ds_read_b64_tr_b16 v[178:179], v239 offset:16256
    ds_read_b64_tr_b16 v[180:181], v239 offset:14496
    buffer_load_dwordx4 v235, s[20:23], s63 offen lds
    s_waitcnt lgkmcnt(11)
    v_mfma_f32_32x32x16_bf16 v[112:127], v[212:215], a[196:199], v[112:127]
    ds_read_b64_tr_b16 v[182:183], v239 offset:16288
    ds_read_b64_tr_b16 v[184:185], v239 offset:14528
    ds_read_b64_tr_b16 v[186:187], v239 offset:16320
    s_waitcnt lgkmcnt(12)
    v_mfma_f32_32x32x16_bf16 v[16:31], v[160:163], a[200:203], v[16:31]
    s_waitcnt lgkmcnt(10)
    v_mfma_f32_32x32x16_bf16 v[32:47], v[164:167], a[200:203], v[32:47]
    s_add_u32 m0, s61, 32768
    ds_read_b64_tr_b16 v[188:189], v239 offset:17920
    buffer_load_dwordx4 v236, s[20:23], s63 offen lds
    ds_read_b64_tr_b16 v[190:191], v239 offset:19712
    s_add_u32 m0, s61, 33792
    s_waitcnt lgkmcnt(10)
    v_mfma_f32_32x32x16_bf16 v[48:63], v[168:171], a[200:203], v[48:63]
    ds_read_b64_tr_b16 v[192:193], v239 offset:17952
    buffer_load_dwordx4 v237, s[20:23], s63 offen lds
    ds_read_b64_tr_b16 v[194:195], v239 offset:19744
    s_add_u32 s28, s66, 65536
    ds_read_b64_tr_b16 v[196:197], v239 offset:17984
    s_waitcnt lgkmcnt(11)
    v_mfma_f32_32x32x16_bf16 v[64:79], v[172:175], a[200:203], v[64:79]
    s_add_u32 m0, s68, 8192
    ds_read_b64_tr_b16 v[198:199], v239 offset:19776
    buffer_load_dwordx4 v241, s[16:19], s28 offen lds
    ds_read_b64_tr_b16 v[200:201], v239 offset:18016
    s_add_u32 s28, s66, 73728
    s_waitcnt lgkmcnt(11)
    v_mfma_f32_32x32x16_bf16 v[80:95], v[176:179], a[200:203], v[80:95]
    s_add_u32 m0, s68, 9216
    ds_read_b64_tr_b16 v[202:203], v239 offset:19808
    buffer_load_dwordx4 v241, s[16:19], s28 offen lds
    ds_read_b64_tr_b16 v[204:205], v239 offset:18048
    s_add_u32 s28, s66, 81920
    s_waitcnt lgkmcnt(11)
    v_mfma_f32_32x32x16_bf16 v[96:111], v[180:183], a[200:203], v[96:111]
    ds_read_b64_tr_b16 v[206:207], v239 offset:19840
    s_add_u32 m0, s68, 10240
    ds_read_b64_tr_b16 v[208:209], v239 offset:18080
    buffer_load_dwordx4 v241, s[16:19], s28 offen lds
    ds_read_b64_tr_b16 v[210:211], v239 offset:19872
    s_waitcnt lgkmcnt(12)
    v_mfma_f32_32x32x16_bf16 v[112:127], v[184:187], a[200:203], v[112:127]
    s_add_u32 s28, s66, 90112
    ds_read_b64_tr_b16 v[212:213], v239 offset:18112
    s_add_u32 m0, s68, 11264
    ds_read_b64_tr_b16 v[214:215], v239 offset:19904
    buffer_load_dwordx4 v241, s[16:19], s28 offen lds
    s_waitcnt lgkmcnt(12)
    v_mfma_f32_32x32x16_bf16 v[16:31], v[188:191], a[204:207], v[16:31]
    s_waitcnt vmcnt(27)
    s_waitcnt lgkmcnt(0)
    s_barrier
    v_mfma_f32_32x32x16_bf16 v[32:47], v[192:195], a[204:207], v[32:47]
    s_add_u32 m0, s61, 34816
    ds_read_b64_tr_b16 v[160:161], v239 offset:28672
    ds_read_b64_tr_b16 v[162:163], v239 offset:30464
    buffer_load_dwordx4 v238, s[20:23], s63 offen lds
    ds_read_b64_tr_b16 v[164:165], v239 offset:28704
    v_mfma_f32_32x32x16_bf16 v[48:63], v[196:199], a[204:207], v[48:63]
    s_waitcnt vmcnt(16)
    ds_read_b64_tr_b16 v[166:167], v239 offset:30496
    ds_read_b64_tr_b16 a[0:1], v216 offset:0
    ds_read_b64_tr_b16 v[168:169], v239 offset:28736
    v_mfma_f32_32x32x16_bf16 v[64:79], v[200:203], a[204:207], v[64:79]
    ds_read_b64_tr_b16 v[170:171], v239 offset:30528
    ds_read_b64_tr_b16 a[2:3], v216 offset:1024
    ds_read_b64_tr_b16 v[172:173], v239 offset:28768
    ds_read_b64_tr_b16 a[4:5], v217 offset:0
    v_mfma_f32_32x32x16_bf16 v[80:95], v[204:207], a[204:207], v[80:95]
    ds_read_b64_tr_b16 v[174:175], v239 offset:30560
    ds_read_b64_tr_b16 a[6:7], v217 offset:1024
    ds_read_b64_tr_b16 v[176:177], v239 offset:28800
    ds_read_b64_tr_b16 a[8:9], v216 offset:2048
    v_mfma_f32_32x32x16_bf16 v[96:111], v[208:211], a[204:207], v[96:111]
    ds_read_b64_tr_b16 v[178:179], v239 offset:30592
    ds_read_b64_tr_b16 v[180:181], v239 offset:28832
    ds_read_b64_tr_b16 a[10:11], v216 offset:3072
    ds_read_b64_tr_b16 v[182:183], v239 offset:30624
    v_mfma_f32_32x32x16_bf16 v[112:127], v[212:215], a[204:207], v[112:127]
    ds_read_b64_tr_b16 a[12:13], v217 offset:2048
    ds_read_b64_tr_b16 v[184:185], v239 offset:28864
    ds_read_b64_tr_b16 a[14:15], v217 offset:3072
    ds_read_b64_tr_b16 v[186:187], v239 offset:30656
    s_waitcnt lgkmcnt(15)
    v_mfma_f32_32x32x16_bf16 v[16:31], v[160:163], a[208:211], v[16:31]
    v_mfma_f32_32x32x16_bf16 v[32:47], v[164:167], a[208:211], v[32:47]
    s_waitcnt lgkmcnt(1)
    ds_read_b64_tr_b16 v[188:189], v239 offset:32256
    ds_read_b64_tr_b16 v[190:191], v239 offset:34048
    s_add_u32 s28, s66, 98304
    ds_read_b64_tr_b16 v[192:193], v239 offset:32288
    v_mfma_f32_32x32x16_bf16 v[48:63], v[168:171], a[208:211], v[48:63]
    s_add_u32 m0, s68, 0
    ds_read_b64_tr_b16 v[194:195], v239 offset:34080
    buffer_load_dwordx4 v241, s[16:19], s28 offen lds
    ds_read_b64_tr_b16 v[196:197], v239 offset:32320
    v_mfma_f32_32x32x16_bf16 v[64:79], v[172:175], a[208:211], v[64:79]
    s_add_u32 s28, s66, 106496
    ds_read_b64_tr_b16 v[198:199], v239 offset:34112
    s_add_u32 m0, s68, 1024
    ds_read_b64_tr_b16 v[200:201], v239 offset:32352
    buffer_load_dwordx4 v241, s[16:19], s28 offen lds
    v_mfma_f32_32x32x16_bf16 v[80:95], v[176:179], a[208:211], v[80:95]
    ds_read_b64_tr_b16 v[202:203], v239 offset:34144
    s_add_u32 s28, s66, 114688
    ds_read_b64_tr_b16 v[204:205], v239 offset:32384
    s_add_u32 m0, s68, 2048
    v_mfma_f32_32x32x16_bf16 v[96:111], v[180:183], a[208:211], v[96:111]
    ds_read_b64_tr_b16 v[206:207], v239 offset:34176
    buffer_load_dwordx4 v241, s[16:19], s28 offen lds
    ds_read_b64_tr_b16 v[208:209], v239 offset:32416
    s_add_u32 s28, s66, 122880
    ds_read_b64_tr_b16 v[210:211], v239 offset:34208
    s_waitcnt lgkmcnt(12)
    v_mfma_f32_32x32x16_bf16 v[112:127], v[184:187], a[208:211], v[112:127]
    s_add_u32 m0, s68, 3072
    ds_read_b64_tr_b16 v[212:213], v239 offset:32448
    buffer_load_dwordx4 v241, s[16:19], s28 offen lds
    ds_read_b64_tr_b16 v[214:215], v239 offset:34240
    s_waitcnt lgkmcnt(12)
    v_mfma_f32_32x32x16_bf16 v[16:31], v[188:191], a[212:215], v[16:31]
    s_waitcnt lgkmcnt(10)
    v_mfma_f32_32x32x16_bf16 v[32:47], v[192:195], a[212:215], v[32:47]
    s_waitcnt vmcnt(13)
    ds_read_b64_tr_b16 v[160:161], v239 offset:43008
    ds_read_b64_tr_b16 v[162:163], v239 offset:44800
    ds_read_b64_tr_b16 a[16:17], v216 offset:4096
    s_waitcnt lgkmcnt(11)
    v_mfma_f32_32x32x16_bf16 v[48:63], v[196:199], a[212:215], v[48:63]
    ds_read_b64_tr_b16 v[164:165], v239 offset:43040
    ds_read_b64_tr_b16 v[166:167], v239 offset:44832
    ds_read_b64_tr_b16 a[18:19], v216 offset:5120
    ds_read_b64_tr_b16 v[168:169], v239 offset:43072
    s_waitcnt lgkmcnt(13)
    v_mfma_f32_32x32x16_bf16 v[64:79], v[200:203], a[212:215], v[64:79]
    ds_read_b64_tr_b16 a[20:21], v217 offset:4096
    ds_read_b64_tr_b16 v[170:171], v239 offset:44864
    ds_read_b64_tr_b16 v[172:173], v239 offset:43104
    ds_read_b64_tr_b16 a[22:23], v217 offset:5120
    s_waitcnt lgkmcnt(15)
    v_mfma_f32_32x32x16_bf16 v[80:95], v[204:207], a[212:215], v[80:95]
    ds_read_b64_tr_b16 v[174:175], v239 offset:44896
    ds_read_b64_tr_b16 a[24:25], v216 offset:6144
    ds_read_b64_tr_b16 v[176:177], v239 offset:43136
    ds_read_b64_tr_b16 v[178:179], v239 offset:44928
    s_waitcnt lgkmcnt(15)
    v_mfma_f32_32x32x16_bf16 v[96:111], v[208:211], a[212:215], v[96:111]
    ds_read_b64_tr_b16 a[26:27], v216 offset:7168
    ds_read_b64_tr_b16 v[180:181], v239 offset:43168
    ds_read_b64_tr_b16 a[28:29], v217 offset:6144
    ds_read_b64_tr_b16 v[182:183], v239 offset:44960
    v_mfma_f32_32x32x16_bf16 v[112:127], v[212:215], a[212:215], v[112:127]
    ds_read_b64_tr_b16 v[184:185], v239 offset:43200
    ds_read_b64_tr_b16 a[30:31], v217 offset:7168
    ds_read_b64_tr_b16 v[186:187], v239 offset:44992
    s_waitcnt lgkmcnt(15)
    v_mfma_f32_32x32x16_bf16 v[16:31], v[160:163], a[216:219], v[16:31]
    v_mfma_f32_32x32x16_bf16 v[32:47], v[164:167], a[216:219], v[32:47]
    s_waitcnt lgkmcnt(1)
    ds_read_b64_tr_b16 v[188:189], v239 offset:46592
    ds_read_b64_tr_b16 v[190:191], v239 offset:48384
    s_add_u32 s28, s66, 131072
    ds_read_b64_tr_b16 v[192:193], v239 offset:46624
    v_mfma_f32_32x32x16_bf16 v[48:63], v[168:171], a[216:219], v[48:63]
    s_add_u32 m0, s68, 4096
    ds_read_b64_tr_b16 v[194:195], v239 offset:48416
    buffer_load_dwordx4 v241, s[16:19], s28 offen lds
    ds_read_b64_tr_b16 v[196:197], v239 offset:46656
    v_mfma_f32_32x32x16_bf16 v[64:79], v[172:175], a[216:219], v[64:79]
    s_add_u32 s28, s66, 139264
    ds_read_b64_tr_b16 v[198:199], v239 offset:48448
    s_add_u32 m0, s68, 5120
    ds_read_b64_tr_b16 v[200:201], v239 offset:46688
    buffer_load_dwordx4 v241, s[16:19], s28 offen lds
    v_mfma_f32_32x32x16_bf16 v[80:95], v[176:179], a[216:219], v[80:95]
    ds_read_b64_tr_b16 v[202:203], v239 offset:48480
    s_add_u32 s28, s66, 147456
    ds_read_b64_tr_b16 v[204:205], v239 offset:46720
    s_add_u32 m0, s68, 6144
    v_mfma_f32_32x32x16_bf16 v[96:111], v[180:183], a[216:219], v[96:111]
    ds_read_b64_tr_b16 v[206:207], v239 offset:48512
    buffer_load_dwordx4 v241, s[16:19], s28 offen lds
    ds_read_b64_tr_b16 v[208:209], v239 offset:46752
    s_add_u32 s28, s66, 155648
    ds_read_b64_tr_b16 v[210:211], v239 offset:48544
    s_waitcnt lgkmcnt(12)
    v_mfma_f32_32x32x16_bf16 v[112:127], v[184:187], a[216:219], v[112:127]
    s_add_u32 m0, s68, 7168
    ds_read_b64_tr_b16 v[212:213], v239 offset:46784
    buffer_load_dwordx4 v241, s[16:19], s28 offen lds
    ds_read_b64_tr_b16 v[214:215], v239 offset:48576
    s_waitcnt lgkmcnt(12)
    v_mfma_f32_32x32x16_bf16 v[16:31], v[188:191], a[220:223], v[16:31]
    s_waitcnt vmcnt(8)
    s_waitcnt lgkmcnt(0)
    s_barrier
    v_mfma_f32_32x32x16_bf16 v[32:47], v[192:195], a[220:223], v[32:47]
    ds_read_b64_tr_b16 v[160:161], v240 offset:0
    ds_read_b64_tr_b16 a[32:33], v216 offset:8192
    v_mfma_f32_32x32x16_bf16 v[48:63], v[196:199], a[220:223], v[48:63]
    ds_read_b64_tr_b16 a[34:35], v216 offset:9216
    ds_read_b64_tr_b16 v[162:163], v240 offset:1792
    v_mfma_f32_32x32x16_bf16 v[64:79], v[200:203], a[220:223], v[64:79]
    ds_read_b64_tr_b16 a[36:37], v217 offset:8192
    ds_read_b64_tr_b16 a[38:39], v217 offset:9216
    v_mfma_f32_32x32x16_bf16 v[80:95], v[204:207], a[220:223], v[80:95]
    ds_read_b64_tr_b16 v[164:165], v240 offset:3584
    ds_read_b64_tr_b16 a[40:41], v216 offset:10240
    v_mfma_f32_32x32x16_bf16 v[96:111], v[208:211], a[220:223], v[96:111]
    ds_read_b64_tr_b16 a[42:43], v216 offset:11264
    ds_read_b64_tr_b16 v[166:167], v240 offset:5376
    v_mfma_f32_32x32x16_bf16 v[112:127], v[212:215], a[220:223], v[112:127]
    ds_read_b64_tr_b16 a[44:45], v217 offset:10240
    ds_read_b64_tr_b16 a[46:47], v217 offset:11264
    s_waitcnt lgkmcnt(8)
    v_mfma_f32_32x32x16_bf16 v[16:31], v[160:163], a[224:227], v[16:31]
    ds_read_b64_tr_b16 v[168:169], v240 offset:14336
    ds_read_b64_tr_b16 v[170:171], v240 offset:16128
    s_waitcnt vmcnt(4)
    ds_read_b64_tr_b16 a[48:49], v216 offset:0
    ds_read_b64_tr_b16 a[50:51], v216 offset:1024
    ds_read_b64_tr_b16 a[52:53], v217 offset:0
    ds_read_b64_tr_b16 a[54:55], v217 offset:1024
    s_waitcnt lgkmcnt(8)
    v_mfma_f32_32x32x16_bf16 v[16:31], v[164:167], a[228:231], v[16:31]
    ds_read_b64_tr_b16 v[172:173], v240 offset:17920
    ds_read_b64_tr_b16 v[174:175], v240 offset:19712
    ds_read_b64_tr_b16 a[56:57], v216 offset:2048
    ds_read_b64_tr_b16 a[58:59], v216 offset:3072
    ds_read_b64_tr_b16 a[60:61], v217 offset:2048
    ds_read_b64_tr_b16 a[62:63], v217 offset:3072
    s_waitcnt lgkmcnt(10)
    v_mfma_f32_32x32x16_bf16 v[16:31], v[168:171], a[232:235], v[16:31]
    ds_read_b64_tr_b16 v[176:177], v240 offset:28672
    ds_read_b64_tr_b16 v[178:179], v240 offset:30464
    s_add_u32 s28, s66, 163840
    s_add_u32 m0, s70, 0
    s_nop 0
    buffer_load_dwordx4 v241, s[16:19], s28 offen lds
    s_add_u32 s28, s66, 172032
    s_waitcnt lgkmcnt(6)
    v_mfma_f32_32x32x16_bf16 v[16:31], v[172:175], a[236:239], v[16:31]
    ds_read_b64_tr_b16 v[180:181], v240 offset:32256
    ds_read_b64_tr_b16 v[182:183], v240 offset:34048
    s_add_u32 m0, s70, 1024
    s_nop 0
    buffer_load_dwordx4 v241, s[16:19], s28 offen lds
    s_add_u32 s28, s66, 180224
    s_add_u32 m0, s70, 2048
    s_waitcnt lgkmcnt(2)
    v_mfma_f32_32x32x16_bf16 v[16:31], v[176:179], a[240:243], v[16:31]
    ds_read_b64_tr_b16 v[184:185], v240 offset:43008
    ds_read_b64_tr_b16 v[186:187], v240 offset:44800
    buffer_load_dwordx4 v241, s[16:19], s28 offen lds
    s_add_u32 s28, s66, 188416
    s_add_u32 m0, s70, 3072
    s_nop 0
    buffer_load_dwordx4 v241, s[16:19], s28 offen lds
    s_waitcnt lgkmcnt(2)
    v_mfma_f32_32x32x16_bf16 v[16:31], v[180:183], a[244:247], v[16:31]
    ds_read_b64_tr_b16 v[188:189], v240 offset:46592
    ds_read_b64_tr_b16 v[190:191], v240 offset:48384
    s_add_u32 s28, s66, 196608
    s_add_u32 m0, s70, 4096
    s_nop 0
    buffer_load_dwordx4 v241, s[16:19], s28 offen lds
    s_add_u32 s28, s66, 204800
    s_waitcnt lgkmcnt(2)
    v_mfma_f32_32x32x16_bf16 v[16:31], v[184:187], a[248:251], v[16:31]
    ds_read_b64_tr_b16 v[192:193], v240 offset:32
    ds_read_b64_tr_b16 v[194:195], v240 offset:1824
    s_add_u32 m0, s70, 5120
    s_nop 0
    buffer_load_dwordx4 v241, s[16:19], s28 offen lds
    s_add_u32 s28, s66, 212992
    s_add_u32 m0, s70, 6144
    s_waitcnt lgkmcnt(2)
    v_mfma_f32_32x32x16_bf16 v[16:31], v[188:191], a[252:255], v[16:31]
    ds_read_b64_tr_b16 v[196:197], v240 offset:3616
    ds_read_b64_tr_b16 v[198:199], v240 offset:5408
    buffer_load_dwordx4 v241, s[16:19], s28 offen lds
    s_add_u32 s28, s66, 221184
    s_add_u32 m0, s70, 7168
    s_nop 0
    buffer_load_dwordx4 v241, s[16:19], s28 offen lds
    s_waitcnt lgkmcnt(2)
    v_mfma_f32_32x32x16_bf16 v[32:47], v[192:195], a[224:227], v[32:47]
    ds_read_b64_tr_b16 v[200:201], v240 offset:14368
    ds_read_b64_tr_b16 v[202:203], v240 offset:16160
    s_nop 0
    v_exp_f32 v16, v16
    v_exp_f32 v17, v17
    v_exp_f32 v18, v18
    v_exp_f32 v19, v19
    v_exp_f32 v20, v20
    v_exp_f32 v21, v21
    s_waitcnt lgkmcnt(2)
    v_mfma_f32_32x32x16_bf16 v[32:47], v[196:199], a[228:231], v[32:47]
    ds_read_b64_tr_b16 v[204:205], v240 offset:17952
    ds_read_b64_tr_b16 v[206:207], v240 offset:19744
    v_exp_f32 v22, v22
    v_exp_f32 v23, v23
    v_add_f32 v16, 1.0, v16
    v_add_f32 v17, 1.0, v17
    v_add_f32 v18, 1.0, v18
    v_add_f32 v19, 1.0, v19
    v_add_f32 v20, 1.0, v20
    v_add_f32 v21, 1.0, v21
    s_waitcnt lgkmcnt(2)
    v_mfma_f32_32x32x16_bf16 v[32:47], v[200:203], a[232:235], v[32:47]
    ds_read_b64_tr_b16 v[208:209], v240 offset:28704
    ds_read_b64_tr_b16 v[210:211], v240 offset:30496
    v_add_f32 v22, 1.0, v22
    v_add_f32 v23, 1.0, v23
    v_rcp_f32 v16, v16
    v_rcp_f32 v17, v17
    v_rcp_f32 v18, v18
    v_rcp_f32 v19, v19
    v_rcp_f32 v20, v20
    s_waitcnt lgkmcnt(2)
    v_mfma_f32_32x32x16_bf16 v[32:47], v[204:207], a[236:239], v[32:47]
    ds_read_b64_tr_b16 v[212:213], v240 offset:32288
    ds_read_b64_tr_b16 v[214:215], v240 offset:34080
    v_rcp_f32 v21, v21
    v_rcp_f32 v22, v22
    v_rcp_f32 v23, v23
    v_mul_f32 v16, v16, v24
    v_mul_f32 v17, v17, v25
    v_mul_f32 v18, v18, v26
    v_mul_f32 v19, v19, v27
    s_waitcnt lgkmcnt(2)
    v_mfma_f32_32x32x16_bf16 v[32:47], v[208:211], a[240:243], v[32:47]
    ds_read_b64_tr_b16 v[160:161], v240 offset:43040
    ds_read_b64_tr_b16 v[162:163], v240 offset:44832
    v_mul_f32 v20, v20, v28
    v_mul_f32 v21, v21, v29
    v_mul_f32 v22, v22, v30
    v_mul_f32 v23, v23, v31
    v_cvt_pk_bf16_f32 v24, v16, v17
    v_cvt_pk_bf16_f32 v25, v18, v19
    v_cvt_pk_bf16_f32 v26, v20, v21
    v_cvt_pk_bf16_f32 v27, v22, v23
    buffer_store_dwordx4 v[24:27], v1, s[12:15], s82 offen offset:0 sc1
    s_waitcnt vmcnt(9)
    ds_read_b64_tr_b16 a[64:65], v216 offset:4096
    s_waitcnt lgkmcnt(3)
    v_mfma_f32_32x32x16_bf16 v[32:47], v[212:215], a[244:247], v[32:47]
    ds_read_b64_tr_b16 v[164:165], v240 offset:46624
    ds_read_b64_tr_b16 v[166:167], v240 offset:48416
    ds_read_b64_tr_b16 a[66:67], v216 offset:5120
    ds_read_b64_tr_b16 a[68:69], v217 offset:4096
    ds_read_b64_tr_b16 a[70:71], v217 offset:5120
    ds_read_b64_tr_b16 a[72:73], v216 offset:6144
    ds_read_b64_tr_b16 a[74:75], v216 offset:7168
    ds_read_b64_tr_b16 a[76:77], v217 offset:6144
    ds_read_b64_tr_b16 a[78:79], v217 offset:7168
    s_add_u32 s28, s66, 229376
    s_add_u32 m0, s68, 8192
    s_nop 0
    buffer_load_dwordx4 v241, s[16:19], s28 offen lds
    s_waitcnt lgkmcnt(10)
    v_mfma_f32_32x32x16_bf16 v[32:47], v[160:163], a[248:251], v[32:47]
    ds_read_b64_tr_b16 v[168:169], v240 offset:64
    ds_read_b64_tr_b16 v[170:171], v240 offset:1856
    s_add_u32 s28, s66, 237568
    s_add_u32 m0, s68, 9216
    s_nop 0
    buffer_load_dwordx4 v241, s[16:19], s28 offen lds
    s_add_u32 s28, s66, 245760
    s_add_u32 m0, s68, 10240
    s_nop 0
    buffer_load_dwordx4 v241, s[16:19], s28 offen lds
    s_add_u32 s28, s66, 253952
    s_add_u32 m0, s68, 11264
    s_nop 0
    buffer_load_dwordx4 v241, s[16:19], s28 offen lds
    s_add_u32 s28, s66, 262144
    s_add_u32 m0, s70, 8192
    s_waitcnt lgkmcnt(9)
    v_mfma_f32_32x32x16_bf16 v[32:47], v[164:167], a[252:255], v[32:47]
    ds_read_b64_tr_b16 v[172:173], v240 offset:3648
    ds_read_b64_tr_b16 v[174:175], v240 offset:5440
    buffer_load_dwordx4 v241, s[16:19], s28 offen lds
    s_add_u32 s28, s66, 270336
    s_add_u32 m0, s70, 9216
    s_nop 0
    buffer_load_dwordx4 v241, s[16:19], s28 offen lds
    s_add_u32 s28, s66, 278528
    s_add_u32 m0, s70, 10240
    s_nop 0
    buffer_load_dwordx4 v241, s[16:19], s28 offen lds
    s_add_u32 s28, s66, 286720
    s_add_u32 m0, s70, 11264
    s_nop 0
    buffer_load_dwordx4 v241, s[16:19], s28 offen lds
    s_waitcnt lgkmcnt(2)
    v_mfma_f32_32x32x16_bf16 v[48:63], v[168:171], a[224:227], v[48:63]
    ds_read_b64_tr_b16 v[176:177], v240 offset:14400
    ds_read_b64_tr_b16 v[178:179], v240 offset:16192
    v_exp_f32 v32, v32
    v_exp_f32 v33, v33
    v_exp_f32 v34, v34
    v_exp_f32 v35, v35
    v_exp_f32 v36, v36
    s_waitcnt lgkmcnt(2)
    v_mfma_f32_32x32x16_bf16 v[48:63], v[172:175], a[228:231], v[48:63]
    ds_read_b64_tr_b16 v[180:181], v240 offset:17984
    ds_read_b64_tr_b16 v[182:183], v240 offset:19776
    v_exp_f32 v37, v37
    v_exp_f32 v38, v38
    v_exp_f32 v39, v39
    v_add_f32 v32, 1.0, v32
    v_add_f32 v33, 1.0, v33
    v_add_f32 v34, 1.0, v34
    s_waitcnt lgkmcnt(2)
    v_mfma_f32_32x32x16_bf16 v[48:63], v[176:179], a[232:235], v[48:63]
    ds_read_b64_tr_b16 v[184:185], v240 offset:28736
    ds_read_b64_tr_b16 v[186:187], v240 offset:30528
    v_add_f32 v35, 1.0, v35
    v_add_f32 v36, 1.0, v36
    v_add_f32 v37, 1.0, v37
    v_add_f32 v38, 1.0, v38
    v_add_f32 v39, 1.0, v39
    v_rcp_f32 v32, v32
    v_rcp_f32 v33, v33
    v_rcp_f32 v34, v34
    s_waitcnt lgkmcnt(2)
    v_mfma_f32_32x32x16_bf16 v[48:63], v[180:183], a[236:239], v[48:63]
    ds_read_b64_tr_b16 v[188:189], v240 offset:32320
    ds_read_b64_tr_b16 v[190:191], v240 offset:34112
    v_rcp_f32 v35, v35
    v_rcp_f32 v36, v36
    v_rcp_f32 v37, v37
    v_rcp_f32 v38, v38
    s_waitcnt lgkmcnt(2)
    v_mfma_f32_32x32x16_bf16 v[48:63], v[184:187], a[240:243], v[48:63]
    ds_read_b64_tr_b16 v[192:193], v240 offset:43072
    ds_read_b64_tr_b16 v[194:195], v240 offset:44864
    v_rcp_f32 v39, v39
    v_mul_f32 v32, v32, v40
    v_mul_f32 v33, v33, v41
    v_mul_f32 v34, v34, v42
    v_mul_f32 v35, v35, v43
    v_mul_f32 v36, v36, v44
    v_mul_f32 v37, v37, v45
    v_mul_f32 v38, v38, v46
    s_waitcnt lgkmcnt(2)
    v_mfma_f32_32x32x16_bf16 v[48:63], v[188:191], a[244:247], v[48:63]
    ds_read_b64_tr_b16 v[196:197], v240 offset:46656
    ds_read_b64_tr_b16 v[198:199], v240 offset:48448
    v_mul_f32 v39, v39, v47
    v_cvt_pk_bf16_f32 v40, v32, v33
    v_cvt_pk_bf16_f32 v41, v34, v35
    v_cvt_pk_bf16_f32 v42, v36, v37
    v_cvt_pk_bf16_f32 v43, v38, v39
    buffer_store_dwordx4 v[40:43], v1, s[12:15], s82 offen offset:1024 sc1
    s_waitcnt vmcnt(14)
    ds_read_b64_tr_b16 a[80:81], v220 offset:0
    ds_read_b64_tr_b16 a[82:83], v220 offset:1024
    ds_read_b64_tr_b16 a[84:85], v221 offset:0
    s_waitcnt lgkmcnt(5)
    v_mfma_f32_32x32x16_bf16 v[48:63], v[192:195], a[248:251], v[48:63]
    ds_read_b64_tr_b16 v[200:201], v240 offset:96
    ds_read_b64_tr_b16 v[202:203], v240 offset:1888
    ds_read_b64_tr_b16 a[86:87], v221 offset:1024
    ds_read_b64_tr_b16 a[88:89], v220 offset:2048
    ds_read_b64_tr_b16 a[90:91], v220 offset:3072
    ds_read_b64_tr_b16 a[92:93], v221 offset:2048
    ds_read_b64_tr_b16 a[94:95], v221 offset:3072
    s_add_u32 s28, s66, 294912
    s_add_u32 m0, s68, 0
    s_nop 0
    buffer_load_dwordx4 v241, s[16:19], s28 offen lds
    s_waitcnt lgkmcnt(10)
    v_mfma_f32_32x32x16_bf16 v[48:63], v[196:199], a[252:255], v[48:63]
    ds_read_b64_tr_b16 v[204:205], v240 offset:3680
    ds_read_b64_tr_b16 v[206:207], v240 offset:5472
    s_add_u32 s28, s66, 303104
    s_add_u32 m0, s68, 1024
    s_nop 0
    buffer_load_dwordx4 v241, s[16:19], s28 offen lds
    s_add_u32 s28, s66, 311296
    s_add_u32 m0, s68, 2048
    s_nop 0
    buffer_load_dwordx4 v241, s[16:19], s28 offen lds
    s_add_u32 s28, s66, 319488
    s_add_u32 m0, s68, 3072
    s_nop 0
    buffer_load_dwordx4 v241, s[16:19], s28 offen lds
    s_waitcnt lgkmcnt(7)
    v_mfma_f32_32x32x16_bf16 v[64:79], v[200:203], a[224:227], v[64:79]
    ds_read_b64_tr_b16 v[208:209], v240 offset:14432
    ds_read_b64_tr_b16 v[210:211], v240 offset:16224
    v_exp_f32 v48, v48
    v_exp_f32 v49, v49
    v_exp_f32 v50, v50
    v_exp_f32 v51, v51
    v_exp_f32 v52, v52
    s_waitcnt lgkmcnt(2)
    v_mfma_f32_32x32x16_bf16 v[64:79], v[204:207], a[228:231], v[64:79]
    ds_read_b64_tr_b16 v[212:213], v240 offset:18016
    ds_read_b64_tr_b16 v[214:215], v240 offset:19808
    v_exp_f32 v53, v53
    v_exp_f32 v54, v54
    v_exp_f32 v55, v55
    v_add_f32 v48, 1.0, v48
    v_add_f32 v49, 1.0, v49
    v_add_f32 v50, 1.0, v50
    s_waitcnt lgkmcnt(2)
    v_mfma_f32_32x32x16_bf16 v[64:79], v[208:211], a[232:235], v[64:79]
    ds_read_b64_tr_b16 v[160:161], v240 offset:28768
    ds_read_b64_tr_b16 v[162:163], v240 offset:30560
    v_add_f32 v51, 1.0, v51
    v_add_f32 v52, 1.0, v52
    v_add_f32 v53, 1.0, v53
    v_add_f32 v54, 1.0, v54
    v_add_f32 v55, 1.0, v55
    v_rcp_f32 v48, v48
    v_rcp_f32 v49, v49
    v_rcp_f32 v50, v50
    s_waitcnt lgkmcnt(2)
    v_mfma_f32_32x32x16_bf16 v[64:79], v[212:215], a[236:239], v[64:79]
    ds_read_b64_tr_b16 v[164:165], v240 offset:32352
    ds_read_b64_tr_b16 v[166:167], v240 offset:34144
    v_rcp_f32 v51, v51
    v_rcp_f32 v52, v52
    v_rcp_f32 v53, v53
    v_rcp_f32 v54, v54
    s_waitcnt lgkmcnt(2)
    v_mfma_f32_32x32x16_bf16 v[64:79], v[160:163], a[240:243], v[64:79]
    ds_read_b64_tr_b16 v[168:169], v240 offset:43104
    ds_read_b64_tr_b16 v[170:171], v240 offset:44896
    v_rcp_f32 v55, v55
    v_mul_f32 v48, v48, v56
    v_mul_f32 v49, v49, v57
    v_mul_f32 v50, v50, v58
    v_mul_f32 v51, v51, v59
    v_mul_f32 v52, v52, v60
    v_mul_f32 v53, v53, v61
    v_mul_f32 v54, v54, v62
    s_waitcnt lgkmcnt(2)
    v_mfma_f32_32x32x16_bf16 v[64:79], v[164:167], a[244:247], v[64:79]
    ds_read_b64_tr_b16 v[172:173], v240 offset:46688
    ds_read_b64_tr_b16 v[174:175], v240 offset:48480
    v_mul_f32 v55, v55, v63
    v_cvt_pk_bf16_f32 v56, v48, v49
    v_cvt_pk_bf16_f32 v57, v50, v51
    v_cvt_pk_bf16_f32 v58, v52, v53
    v_cvt_pk_bf16_f32 v59, v54, v55
    buffer_store_dwordx4 v[56:59], v1, s[12:15], s82 offen offset:2048 sc1
    s_waitcnt vmcnt(15)
    ds_read_b64_tr_b16 a[96:97], v220 offset:4096
    ds_read_b64_tr_b16 a[98:99], v220 offset:5120
    ds_read_b64_tr_b16 a[100:101], v221 offset:4096
    s_waitcnt lgkmcnt(5)
    v_mfma_f32_32x32x16_bf16 v[64:79], v[168:171], a[248:251], v[64:79]
    ds_read_b64_tr_b16 v[176:177], v240 offset:128
    ds_read_b64_tr_b16 v[178:179], v240 offset:1920
    ds_read_b64_tr_b16 a[102:103], v221 offset:5120
    ds_read_b64_tr_b16 a[104:105], v220 offset:6144
    ds_read_b64_tr_b16 a[106:107], v220 offset:7168
    ds_read_b64_tr_b16 a[108:109], v221 offset:6144
    ds_read_b64_tr_b16 a[110:111], v221 offset:7168
    s_add_u32 s28, s66, 327680
    s_add_u32 m0, s68, 4096
    s_nop 0
    buffer_load_dwordx4 v241, s[16:19], s28 offen lds
    s_waitcnt lgkmcnt(10)
    v_mfma_f32_32x32x16_bf16 v[64:79], v[172:175], a[252:255], v[64:79]
    ds_read_b64_tr_b16 v[180:181], v240 offset:3712
    ds_read_b64_tr_b16 v[182:183], v240 offset:5504
    s_add_u32 s28, s66, 335872
    s_add_u32 m0, s68, 5120
    s_nop 0
    buffer_load_dwordx4 v241, s[16:19], s28 offen lds
    s_add_u32 s28, s66, 344064
    s_add_u32 m0, s68, 6144
    s_nop 0
    buffer_load_dwordx4 v241, s[16:19], s28 offen lds
    s_add_u32 s28, s66, 352256
    s_add_u32 m0, s68, 7168
    s_nop 0
    buffer_load_dwordx4 v241, s[16:19], s28 offen lds
    s_waitcnt lgkmcnt(7)
    v_mfma_f32_32x32x16_bf16 v[80:95], v[176:179], a[224:227], v[80:95]
    ds_read_b64_tr_b16 v[184:185], v240 offset:14464
    ds_read_b64_tr_b16 v[186:187], v240 offset:16256
    v_exp_f32 v64, v64
    v_exp_f32 v65, v65
    v_exp_f32 v66, v66
    v_exp_f32 v67, v67
    v_exp_f32 v68, v68
    s_waitcnt lgkmcnt(2)
    v_mfma_f32_32x32x16_bf16 v[80:95], v[180:183], a[228:231], v[80:95]
    ds_read_b64_tr_b16 v[188:189], v240 offset:18048
    ds_read_b64_tr_b16 v[190:191], v240 offset:19840
    v_exp_f32 v69, v69
    v_exp_f32 v70, v70
    v_exp_f32 v71, v71
    v_add_f32 v64, 1.0, v64
    v_add_f32 v65, 1.0, v65
    v_add_f32 v66, 1.0, v66
    s_waitcnt lgkmcnt(2)
    v_mfma_f32_32x32x16_bf16 v[80:95], v[184:187], a[232:235], v[80:95]
    ds_read_b64_tr_b16 v[192:193], v240 offset:28800
    ds_read_b64_tr_b16 v[194:195], v240 offset:30592
    v_add_f32 v67, 1.0, v67
    v_add_f32 v68, 1.0, v68
    v_add_f32 v69, 1.0, v69
    v_add_f32 v70, 1.0, v70
    v_add_f32 v71, 1.0, v71
    v_rcp_f32 v64, v64
    v_rcp_f32 v65, v65
    v_rcp_f32 v66, v66
    s_waitcnt lgkmcnt(2)
    v_mfma_f32_32x32x16_bf16 v[80:95], v[188:191], a[236:239], v[80:95]
    ds_read_b64_tr_b16 v[196:197], v240 offset:32384
    ds_read_b64_tr_b16 v[198:199], v240 offset:34176
    v_rcp_f32 v67, v67
    v_rcp_f32 v68, v68
    v_rcp_f32 v69, v69
    v_rcp_f32 v70, v70
    s_waitcnt lgkmcnt(2)
    v_mfma_f32_32x32x16_bf16 v[80:95], v[192:195], a[240:243], v[80:95]
    ds_read_b64_tr_b16 v[200:201], v240 offset:43136
    ds_read_b64_tr_b16 v[202:203], v240 offset:44928
    v_rcp_f32 v71, v71
    v_mul_f32 v64, v64, v72
    v_mul_f32 v65, v65, v73
    v_mul_f32 v66, v66, v74
    v_mul_f32 v67, v67, v75
    v_mul_f32 v68, v68, v76
    v_mul_f32 v69, v69, v77
    v_mul_f32 v70, v70, v78
    s_waitcnt lgkmcnt(2)
    v_mfma_f32_32x32x16_bf16 v[80:95], v[196:199], a[244:247], v[80:95]
    ds_read_b64_tr_b16 v[204:205], v240 offset:46720
    ds_read_b64_tr_b16 v[206:207], v240 offset:48512
    v_mul_f32 v71, v71, v79
    v_cvt_pk_bf16_f32 v72, v64, v65
    v_cvt_pk_bf16_f32 v73, v66, v67
    v_cvt_pk_bf16_f32 v74, v68, v69
    v_cvt_pk_bf16_f32 v75, v70, v71
    buffer_store_dwordx4 v[72:75], v1, s[12:15], s82 offen offset:3072 sc1
    s_waitcnt vmcnt(15)
    ds_read_b64_tr_b16 a[112:113], v216 offset:8192
    ds_read_b64_tr_b16 a[114:115], v216 offset:9216
    ds_read_b64_tr_b16 a[116:117], v217 offset:8192
    s_waitcnt lgkmcnt(5)
    v_mfma_f32_32x32x16_bf16 v[80:95], v[200:203], a[248:251], v[80:95]
    ds_read_b64_tr_b16 v[208:209], v240 offset:160
    ds_read_b64_tr_b16 v[210:211], v240 offset:1952
    ds_read_b64_tr_b16 a[118:119], v217 offset:9216
    ds_read_b64_tr_b16 a[120:121], v216 offset:10240
    ds_read_b64_tr_b16 a[122:123], v216 offset:11264
    ds_read_b64_tr_b16 a[124:125], v217 offset:10240
    ds_read_b64_tr_b16 a[126:127], v217 offset:11264
    s_add_u32 s28, s66, 360448
    s_add_u32 m0, s70, 0
    s_nop 0
    buffer_load_dwordx4 v241, s[16:19], s28 offen lds
    s_waitcnt lgkmcnt(10)
    v_mfma_f32_32x32x16_bf16 v[80:95], v[204:207], a[252:255], v[80:95]
    ds_read_b64_tr_b16 v[212:213], v240 offset:3744
    ds_read_b64_tr_b16 v[214:215], v240 offset:5536
    s_add_u32 s28, s66, 368640
    s_add_u32 m0, s70, 1024
    s_nop 0
    buffer_load_dwordx4 v241, s[16:19], s28 offen lds
    s_add_u32 s28, s66, 376832
    s_add_u32 m0, s70, 2048
    s_nop 0
    buffer_load_dwordx4 v241, s[16:19], s28 offen lds
    s_add_u32 s28, s66, 385024
    s_add_u32 m0, s70, 3072
    s_nop 0
    buffer_load_dwordx4 v241, s[16:19], s28 offen lds
    s_waitcnt lgkmcnt(7)
    v_mfma_f32_32x32x16_bf16 v[96:111], v[208:211], a[224:227], v[96:111]
    ds_read_b64_tr_b16 v[160:161], v240 offset:14496
    ds_read_b64_tr_b16 v[162:163], v240 offset:16288
    v_exp_f32 v80, v80
    v_exp_f32 v81, v81
    v_exp_f32 v82, v82
    v_exp_f32 v83, v83
    s_waitcnt lgkmcnt(2)
    v_mfma_f32_32x32x16_bf16 v[96:111], v[212:215], a[228:231], v[96:111]
    ds_read_b64_tr_b16 v[164:165], v240 offset:18080
    ds_read_b64_tr_b16 v[166:167], v240 offset:19872
    v_exp_f32 v84, v84
    v_exp_f32 v85, v85
    v_exp_f32 v86, v86
    v_exp_f32 v87, v87
    s_waitcnt lgkmcnt(2)
    v_mfma_f32_32x32x16_bf16 v[96:111], v[160:163], a[232:235], v[96:111]
    ds_read_b64_tr_b16 v[168:169], v240 offset:28832
    ds_read_b64_tr_b16 v[170:171], v240 offset:30624
    v_add_f32 v80, 1.0, v80
    v_add_f32 v81, 1.0, v81
    v_add_f32 v82, 1.0, v82
    v_add_f32 v83, 1.0, v83
    v_add_f32 v84, 1.0, v84
    v_add_f32 v85, 1.0, v85
    v_add_f32 v86, 1.0, v86
    v_add_f32 v87, 1.0, v87
    s_waitcnt lgkmcnt(2)
    v_mfma_f32_32x32x16_bf16 v[96:111], v[164:167], a[236:239], v[96:111]
    ds_read_b64_tr_b16 v[172:173], v240 offset:32416
    ds_read_b64_tr_b16 v[174:175], v240 offset:34208
    v_rcp_f32 v80, v80
    v_rcp_f32 v81, v81
    v_rcp_f32 v82, v82
    v_rcp_f32 v83, v83
    s_waitcnt lgkmcnt(2)
    v_mfma_f32_32x32x16_bf16 v[96:111], v[168:171], a[240:243], v[96:111]
    ds_read_b64_tr_b16 v[176:177], v240 offset:43168
    ds_read_b64_tr_b16 v[178:179], v240 offset:44960
    v_rcp_f32 v84, v84
    v_rcp_f32 v85, v85
    v_rcp_f32 v86, v86
    v_rcp_f32 v87, v87
    s_waitcnt lgkmcnt(2)
    v_mfma_f32_32x32x16_bf16 v[96:111], v[172:175], a[244:247], v[96:111]
    ds_read_b64_tr_b16 v[180:181], v240 offset:46752
    ds_read_b64_tr_b16 v[182:183], v240 offset:48544
    v_mul_f32 v80, v80, v88
    v_mul_f32 v81, v81, v89
    v_mul_f32 v82, v82, v90
    v_mul_f32 v83, v83, v91
    v_mul_f32 v84, v84, v92
    v_mul_f32 v85, v85, v93
    v_mul_f32 v86, v86, v94
    s_waitcnt lgkmcnt(2)
    v_mfma_f32_32x32x16_bf16 v[96:111], v[176:179], a[248:251], v[96:111]
    ds_read_b64_tr_b16 v[184:185], v240 offset:192
    ds_read_b64_tr_b16 v[186:187], v240 offset:1984
    v_mul_f32 v87, v87, v95
    v_cvt_pk_bf16_f32 v88, v80, v81
    v_cvt_pk_bf16_f32 v89, v82, v83
    v_cvt_pk_bf16_f32 v90, v84, v85
    v_cvt_pk_bf16_f32 v91, v86, v87
    buffer_store_dwordx4 v[88:91], v1, s[12:15], s83 offen offset:0 sc1
    s_waitcnt vmcnt(16)
    ds_read_b64_tr_b16 a[128:129], v220 offset:8192
    s_waitcnt lgkmcnt(3)
    v_mfma_f32_32x32x16_bf16 v[96:111], v[180:183], a[252:255], v[96:111]
    ds_read_b64_tr_b16 v[188:189], v240 offset:3776
    ds_read_b64_tr_b16 v[190:191], v240 offset:5568
    ds_read_b64_tr_b16 a[130:131], v220 offset:9216
    ds_read_b64_tr_b16 a[132:133], v221 offset:8192
    ds_read_b64_tr_b16 a[134:135], v221 offset:9216
    ds_read_b64_tr_b16 a[136:137], v220 offset:10240
    ds_read_b64_tr_b16 a[138:139], v220 offset:11264
    ds_read_b64_tr_b16 a[140:141], v221 offset:10240
    ds_read_b64_tr_b16 a[142:143], v221 offset:11264
    s_waitcnt lgkmcnt(10)
    v_mfma_f32_32x32x16_bf16 v[112:127], v[184:187], a[224:227], v[112:127]
    ds_read_b64_tr_b16 v[192:193], v240 offset:14528
    ds_read_b64_tr_b16 v[194:195], v240 offset:16320
    v_exp_f32 v96, v96
    v_exp_f32 v97, v97
    v_exp_f32 v98, v98
    v_exp_f32 v99, v99
    s_waitcnt lgkmcnt(9)
    v_mfma_f32_32x32x16_bf16 v[112:127], v[188:191], a[228:231], v[112:127]
    ds_read_b64_tr_b16 v[196:197], v240 offset:18112
    ds_read_b64_tr_b16 v[198:199], v240 offset:19904
    v_exp_f32 v100, v100
    v_exp_f32 v101, v101
    v_exp_f32 v102, v102
    v_exp_f32 v103, v103
    s_waitcnt lgkmcnt(2)
    v_mfma_f32_32x32x16_bf16 v[112:127], v[192:195], a[232:235], v[112:127]
    ds_read_b64_tr_b16 v[200:201], v240 offset:28864
    ds_read_b64_tr_b16 v[202:203], v240 offset:30656
    v_add_f32 v96, 1.0, v96
    v_add_f32 v97, 1.0, v97
    v_add_f32 v98, 1.0, v98
    v_add_f32 v99, 1.0, v99
    v_add_f32 v100, 1.0, v100
    v_add_f32 v101, 1.0, v101
    v_add_f32 v102, 1.0, v102
    v_add_f32 v103, 1.0, v103
    s_waitcnt lgkmcnt(2)
    v_mfma_f32_32x32x16_bf16 v[112:127], v[196:199], a[236:239], v[112:127]
    ds_read_b64_tr_b16 v[204:205], v240 offset:32448
    ds_read_b64_tr_b16 v[206:207], v240 offset:34240
    v_rcp_f32 v96, v96
    v_rcp_f32 v97, v97
    v_rcp_f32 v98, v98
    v_rcp_f32 v99, v99
    s_waitcnt lgkmcnt(2)
    v_mfma_f32_32x32x16_bf16 v[112:127], v[200:203], a[240:243], v[112:127]
    ds_read_b64_tr_b16 v[208:209], v240 offset:43200
    ds_read_b64_tr_b16 v[210:211], v240 offset:44992
    v_rcp_f32 v100, v100
    v_rcp_f32 v101, v101
    v_rcp_f32 v102, v102
    v_rcp_f32 v103, v103
    s_waitcnt lgkmcnt(2)
    v_mfma_f32_32x32x16_bf16 v[112:127], v[204:207], a[244:247], v[112:127]
    ds_read_b64_tr_b16 v[212:213], v240 offset:46784
    ds_read_b64_tr_b16 v[214:215], v240 offset:48576
    v_mul_f32 v96, v96, v104
    v_mul_f32 v97, v97, v105
    v_mul_f32 v98, v98, v106
    v_mul_f32 v99, v99, v107
    v_mul_f32 v100, v100, v108
    v_mul_f32 v101, v101, v109
    v_mul_f32 v102, v102, v110
    s_waitcnt lgkmcnt(2)
    v_mfma_f32_32x32x16_bf16 v[112:127], v[208:211], a[248:251], v[112:127]
    v_mul_f32 v103, v103, v111
    v_cvt_pk_bf16_f32 v104, v96, v97
    v_cvt_pk_bf16_f32 v105, v98, v99
    v_cvt_pk_bf16_f32 v106, v100, v101
    v_cvt_pk_bf16_f32 v107, v102, v103
    buffer_store_dwordx4 v[104:107], v1, s[12:15], s83 offen offset:1024 sc1
    s_waitcnt vmcnt(12)
    ds_read_b64_tr_b16 a[144:145], v216 offset:0
    s_waitcnt lgkmcnt(1)
    v_mfma_f32_32x32x16_bf16 v[112:127], v[212:215], a[252:255], v[112:127]
    ds_read_b64_tr_b16 a[146:147], v216 offset:1024
    ds_read_b64_tr_b16 a[148:149], v217 offset:0
    ds_read_b64_tr_b16 a[150:151], v217 offset:1024
    ds_read_b64_tr_b16 a[152:153], v216 offset:2048
    ds_read_b64_tr_b16 a[154:155], v216 offset:3072
    ds_read_b64_tr_b16 a[156:157], v217 offset:2048
    ds_read_b64_tr_b16 a[158:159], v217 offset:3072
    s_waitcnt vmcnt(7)
    s_nop 3
    v_exp_f32 v112, v112
    v_exp_f32 v113, v113
    ds_read_b64_tr_b16 a[160:161], v216 offset:4096
    v_exp_f32 v114, v114
    v_exp_f32 v115, v115
    ds_read_b64_tr_b16 a[162:163], v216 offset:5120
    v_exp_f32 v116, v116
    ds_read_b64_tr_b16 a[164:165], v217 offset:4096
    v_exp_f32 v117, v117
    v_exp_f32 v118, v118
    ds_read_b64_tr_b16 a[166:167], v217 offset:5120
    v_exp_f32 v119, v119
    v_pk_add_f32 v[112:113], v[112:113], 1.0 op_sel_hi:[1,0]
    ds_read_b64_tr_b16 a[168:169], v216 offset:6144
    v_pk_add_f32 v[114:115], v[114:115], 1.0 op_sel_hi:[1,0]
    ds_read_b64_tr_b16 a[170:171], v216 offset:7168
    v_pk_add_f32 v[116:117], v[116:117], 1.0 op_sel_hi:[1,0]
    v_pk_add_f32 v[118:119], v[118:119], 1.0 op_sel_hi:[1,0]
    ds_read_b64_tr_b16 a[172:173], v217 offset:6144
    v_rcp_f32 v112, v112
    ds_read_b64_tr_b16 a[174:175], v217 offset:7168
    v_rcp_f32 v113, v113
    v_rcp_f32 v114, v114
    s_waitcnt vmcnt(2)
    v_rcp_f32 v115, v115
    v_rcp_f32 v116, v116
    ds_read_b64_tr_b16 a[176:177], v220 offset:0
    v_rcp_f32 v117, v117
    ds_read_b64_tr_b16 a[178:179], v220 offset:1024
    v_rcp_f32 v118, v118
    v_rcp_f32 v119, v119
    ds_read_b64_tr_b16 a[180:181], v221 offset:0
    v_pk_mul_f32 v[112:113], v[112:113], v[120:121]
    ds_read_b64_tr_b16 a[182:183], v221 offset:1024
    v_pk_mul_f32 v[114:115], v[114:115], v[122:123]
    v_pk_mul_f32 v[116:117], v[116:117], v[124:125]
    ds_read_b64_tr_b16 a[184:185], v220 offset:2048
    v_pk_mul_f32 v[118:119], v[118:119], v[126:127]
    v_cvt_pk_bf16_f32 v120, v112, v113
    ds_read_b64_tr_b16 a[186:187], v220 offset:3072
    v_cvt_pk_bf16_f32 v121, v114, v115
    ds_read_b64_tr_b16 a[188:189], v221 offset:2048
    v_cvt_pk_bf16_f32 v122, v116, v117
    v_cvt_pk_bf16_f32 v123, v118, v119
    ds_read_b64_tr_b16 a[190:191], v221 offset:3072
    buffer_store_dwordx4 v[120:123], v1, s[12:15], s83 offen offset:2048 sc1
    v_mov_b32 v3, s96
    v_mov_b32 v2, 0
    s_waitcnt vmcnt(0)
    s_cmp_eq_u32 s97, 0
    s_cbranch_scc1 L_sigg_20
    s_mov_b64 exec, 1
    buffer_store_dword v3, v2, s[12:15], s90 offen
    s_mov_b64 exec, -1
    s_branch L_sigd_21
L_sigg_20:
    s_barrier
    s_cmp_lg_u32 s3, 0
    s_cbranch_scc1 L_sigd_21
    v_lshlrev_b32 v2, 2, v0
    s_mov_b64 exec, 15
    buffer_store_dword v3, v2, s[12:15], s90 offen sc1
    s_mov_b64 exec, -1
L_sigd_21:
    v_lshlrev_b32 v176, 16, v244
    v_and_b32 v177, s7, v244
    v_lshlrev_b32 v178, 16, v245
    v_and_b32 v179, s7, v245
    v_lshlrev_b32 v180, 16, v246
    v_and_b32 v181, s7, v246
    v_lshlrev_b32 v182, 16, v247
    v_and_b32 v183, s7, v247
    v_lshlrev_b32 v184, 16, v248
    v_and_b32 v185, s7, v248
    v_lshlrev_b32 v186, 16, v249
    v_and_b32 v187, s7, v249
    v_lshlrev_b32 v188, 16, v250
    v_and_b32 v189, s7, v250
    v_lshlrev_b32 v190, 16, v251
    v_and_b32 v191, s7, v251
    v_and_b32 v10, 15, v0
    v_lshlrev_b32 v10, 1, v10
    v_bfe_u32 v15, v0, 4, 1
    v_or_b32 v10, v10, v15
    v_lshlrev_b32 v10, 10, v10
    v_lshrrev_b32 v9, 5, v0
    v_lshl_add_u32 v10, v9, 4, v10
    s_xor_b32 s24, s3, 1
    s_mul_i32 s24, s24, 12288
    s_add_u32 s24, s24, 0
    v_add_u32 v13, s24, v1
    s_xor_b32 s24, s3, 2
    s_mul_i32 s24, s24, 12288
    s_add_u32 s24, s24, 4096
    v_add_u32 v14, s24, v1
    s_xor_b32 s24, s3, 3
    s_mul_i32 s24, s24, 12288
    s_add_u32 s24, s24, 8192
    v_add_u32 v15, s24, v1
    s_mul_i32 s24, s3, 12288
    s_add_u32 s24, s24, 0
    v_add_u32 v12, s24, v1
    s_mov_b32 s20, s54
    s_mov_b32 s21, s55
    s_mov_b32 s22, 0x200000
    s_mov_b32 s23, 0x20000
    s_add_u32 s28, s66, 393216
    s_add_u32 m0, s70, 4096
    s_nop 0
    buffer_load_dwordx4 v241, s[16:19], s28 offen lds
    s_add_u32 s28, s66, 401408
    s_add_u32 m0, s70, 5120
    s_nop 0
    buffer_load_dwordx4 v241, s[16:19], s28 offen lds
    s_add_u32 s28, s66, 409600
    s_add_u32 m0, s70, 6144
    s_nop 0
    buffer_load_dwordx4 v241, s[16:19], s28 offen lds
    s_add_u32 s28, s66, 417792
    s_add_u32 m0, s70, 7168
    s_nop 0
    buffer_load_dwordx4 v241, s[16:19], s28 offen lds
    s_add_u32 s28, s66, 425984
    s_add_u32 m0, s68, 8192
    s_nop 0
    buffer_load_dwordx4 v241, s[16:19], s28 offen lds
    s_add_u32 s28, s66, 434176
    s_add_u32 m0, s68, 9216
    s_nop 0
    buffer_load_dwordx4 v241, s[16:19], s28 offen lds
    s_add_u32 s28, s66, 442368
    s_add_u32 m0, s68, 10240
    s_nop 0
    buffer_load_dwordx4 v241, s[16:19], s28 offen lds
    s_add_u32 s28, s66, 450560
    s_add_u32 m0, s68, 11264
    s_nop 0
    buffer_load_dwordx4 v241, s[16:19], s28 offen lds
    s_waitcnt vmcnt(4)
    ds_read_b64_tr_b16 a[192:193], v220 offset:4096
    ds_read_b64_tr_b16 a[194:195], v220 offset:5120
    ds_read_b64_tr_b16 a[196:197], v221 offset:4096
    ds_read_b64_tr_b16 a[198:199], v221 offset:5120
    ds_read_b64_tr_b16 a[200:201], v220 offset:6144
    ds_read_b64_tr_b16 a[202:203], v220 offset:7168
    ds_read_b64_tr_b16 a[204:205], v221 offset:6144
    ds_read_b64_tr_b16 a[206:207], v221 offset:7168
    s_waitcnt vmcnt(0)
    ds_read_b64_tr_b16 a[208:209], v216 offset:8192
    ds_read_b64_tr_b16 a[210:211], v216 offset:9216
    ds_read_b64_tr_b16 a[212:213], v217 offset:8192
    ds_read_b64_tr_b16 a[214:215], v217 offset:9216
    ds_read_b64_tr_b16 a[216:217], v216 offset:10240
    ds_read_b64_tr_b16 a[218:219], v216 offset:11264
    ds_read_b64_tr_b16 a[220:221], v217 offset:10240
    ds_read_b64_tr_b16 a[222:223], v217 offset:11264
    s_mov_b32 s101, 0
L_spin_22:
    buffer_load_dword v3, v6, s[12:15], s89 offen sc1
    s_waitcnt vmcnt(0)
    v_cmp_eq_u32 vcc, s96, v3
    s_nop 0
    s_cmp_eq_u64 vcc, exec
    s_cbranch_scc1 L_spun_23
    s_add_u32 s101, s101, 1
    s_cmp_lt_u32 s101, 1048576
    s_cbranch_scc1 L_spin_22
L_spun_23:
    buffer_load_dwordx4 v[80:83], v1, s[12:15], s84 offen offset:0 sc1
    buffer_load_dwordx4 v[84:87], v1, s[12:15], s85 offen offset:0 sc1
    buffer_load_dwordx4 v[88:91], v1, s[12:15], s84 offen offset:1024 sc1
    buffer_load_dwordx4 v[92:95], v1, s[12:15], s85 offen offset:1024 sc1
    buffer_load_dwordx4 v[96:99], v1, s[12:15], s84 offen offset:2048 sc1
    buffer_load_dwordx4 v[100:103], v1, s[12:15], s85 offen offset:2048 sc1
    buffer_load_dwordx4 v[104:107], v1, s[12:15], s84 offen offset:3072 sc1
    s_add_u32 s84, s84, 4096
    buffer_load_dwordx4 v[108:111], v1, s[12:15], s85 offen offset:3072 sc1
    s_add_u32 s85, s85, 4096
    buffer_load_dwordx4 v[112:115], v1, s[12:15], s84 offen offset:0 sc1
    buffer_load_dwordx4 v[116:119], v1, s[12:15], s85 offen offset:0 sc1
    buffer_load_dwordx4 v[120:123], v1, s[12:15], s84 offen offset:1024 sc1
    buffer_load_dwordx4 v[124:127], v1, s[12:15], s85 offen offset:1024 sc1
    buffer_load_dwordx4 v[128:131], v1, s[12:15], s84 offen offset:2048 sc1
    buffer_load_dwordx4 v[132:135], v1, s[12:15], s85 offen offset:2048 sc1
    s_waitcnt vmcnt(13)
    v_mfma_f32_32x32x16_bf16 v[16:31], a[0:3], v[80:83], 0
    buffer_load_dwordx4 v[136:139], v1, s[12:15], s84 offen offset:3072 sc1
    s_waitcnt vmcnt(13)
    v_mfma_f32_32x32x16_bf16 v[32:47], a[0:3], v[84:87], 0
    s_add_u32 s84, s84, 4096
    v_mfma_f32_32x32x16_bf16 v[48:63], a[4:7], v[80:83], 0
    buffer_load_dwordx4 v[140:143], v1, s[12:15], s85 offen offset:3072 sc1
    v_mfma_f32_32x32x16_bf16 v[64:79], a[4:7], v[84:87], 0
    s_add_u32 s85, s85, 4096
    s_waitcnt vmcnt(13)
    v_mfma_f32_32x32x16_bf16 v[16:31], a[8:11], v[88:91], v[16:31]
    buffer_load_dwordx4 v[80:83], v1, s[12:15], s84 offen offset:0 sc1
    s_waitcnt vmcnt(13)
    v_mfma_f32_32x32x16_bf16 v[32:47], a[8:11], v[92:95], v[32:47]
    v_mfma_f32_32x32x16_bf16 v[48:63], a[12:15], v[88:91], v[48:63]
    buffer_load_dwordx4 v[84:87], v1, s[12:15], s85 offen offset:0 sc1
    v_mfma_f32_32x32x16_bf16 v[64:79], a[12:15], v[92:95], v[64:79]
    s_waitcnt vmcnt(13)
    v_mfma_f32_32x32x16_bf16 v[16:31], a[16:19], v[96:99], v[16:31]
    buffer_load_dwordx4 v[88:91], v1, s[12:15], s84 offen offset:1024 sc1
    s_waitcnt vmcnt(13)
    v_mfma_f32_32x32x16_bf16 v[32:47], a[16:19], v[100:103], v[32:47]
    v_mfma_f32_32x32x16_bf16 v[48:63], a[20:23], v[96:99], v[48:63]
    buffer_load_dwordx4 v[92:95], v1, s[12:15], s85 offen offset:1024 sc1
    v_mfma_f32_32x32x16_bf16 v[64:79], a[20:23], v[100:103], v[64:79]
    s_waitcnt vmcnt(13)
    v_mfma_f32_32x32x16_bf16 v[16:31], a[24:27], v[104:107], v[16:31]
    buffer_load_dwordx4 v[96:99], v1, s[12:15], s84 offen offset:2048 sc1
    s_waitcnt vmcnt(13)
    v_mfma_f32_32x32x16_bf16 v[32:47], a[24:27], v[108:111], v[32:47]
    v_mfma_f32_32x32x16_bf16 v[48:63], a[28:31], v[104:107], v[48:63]
    buffer_load_dwordx4 v[100:103], v1, s[12:15], s85 offen offset:2048 sc1
    v_mfma_f32_32x32x16_bf16 v[64:79], a[28:31], v[108:111], v[64:79]
    s_waitcnt vmcnt(13)
    v_mfma_f32_32x32x16_bf16 v[16:31], a[32:35], v[112:115], v[16:31]
    buffer_load_dwordx4 v[104:107], v1, s[12:15], s84 offen offset:3072 sc1
    s_waitcnt vmcnt(13)
    v_mfma_f32_32x32x16_bf16 v[32:47], a[32:35], v[116:119], v[32:47]
    s_add_u32 s84, s84, 4096
    v_mfma_f32_32x32x16_bf16 v[48:63], a[36:39], v[112:115], v[48:63]
    buffer_load_dwordx4 v[108:111], v1, s[12:15], s85 offen offset:3072 sc1
    v_mfma_f32_32x32x16_bf16 v[64:79], a[36:39], v[116:119], v[64:79]
    s_add_u32 s85, s85, 4096
    s_waitcnt vmcnt(13)
    v_mfma_f32_32x32x16_bf16 v[16:31], a[40:43], v[120:123], v[16:31]
    buffer_load_dwordx4 v[112:115], v1, s[12:15], s84 offen offset:0 sc1
    s_waitcnt vmcnt(13)
    v_mfma_f32_32x32x16_bf16 v[32:47], a[40:43], v[124:127], v[32:47]
    v_mfma_f32_32x32x16_bf16 v[48:63], a[44:47], v[120:123], v[48:63]
    buffer_load_dwordx4 v[116:119], v1, s[12:15], s85 offen offset:0 sc1
    v_mfma_f32_32x32x16_bf16 v[64:79], a[44:47], v[124:127], v[64:79]
    s_waitcnt vmcnt(13)
    v_mfma_f32_32x32x16_bf16 v[16:31], a[48:51], v[128:131], v[16:31]
    buffer_load_dwordx4 v[120:123], v1, s[12:15], s84 offen offset:1024 sc1
    s_waitcnt vmcnt(13)
    v_mfma_f32_32x32x16_bf16 v[32:47], a[48:51], v[132:135], v[32:47]
    v_mfma_f32_32x32x16_bf16 v[48:63], a[52:55], v[128:131], v[48:63]
    buffer_load_dwordx4 v[124:127], v1, s[12:15], s85 offen offset:1024 sc1
    v_mfma_f32_32x32x16_bf16 v[64:79], a[52:55], v[132:135], v[64:79]
    s_waitcnt vmcnt(13)
    v_mfma_f32_32x32x16_bf16 v[16:31], a[56:59], v[136:139], v[16:31]
    buffer_load_dwordx4 v[128:131], v1, s[12:15], s84 offen offset:2048 sc1
    s_waitcnt vmcnt(13)
    v_mfma_f32_32x32x16_bf16 v[32:47], a[56:59], v[140:143], v[32:47]
    v_mfma_f32_32x32x16_bf16 v[48:63], a[60:63], v[136:139], v[48:63]
    buffer_load_dwordx4 v[132:135], v1, s[12:15], s85 offen offset:2048 sc1
    v_mfma_f32_32x32x16_bf16 v[64:79], a[60:63], v[140:143], v[64:79]
    s_waitcnt vmcnt(13)
    v_mfma_f32_32x32x16_bf16 v[16:31], a[64:67], v[80:83], v[16:31]
    buffer_load_dwordx4 v[136:139], v1, s[12:15], s84 offen offset:3072 sc1
    s_waitcnt vmcnt(13)
    v_mfma_f32_32x32x16_bf16 v[32:47], a[64:67], v[84:87], v[32:47]
    s_add_u32 s84, s84, 4096
    v_mfma_f32_32x32x16_bf16 v[48:63], a[68:71], v[80:83], v[48:63]
    buffer_load_dwordx4 v[140:143], v1, s[12:15], s85 offen offset:3072 sc1
    v_mfma_f32_32x32x16_bf16 v[64:79], a[68:71], v[84:87], v[64:79]
    s_add_u32 s85, s85, 4096
    s_waitcnt vmcnt(13)
    v_mfma_f32_32x32x16_bf16 v[16:31], a[72:75], v[88:91], v[16:31]
    buffer_load_dwordx4 v[80:83], v1, s[12:15], s84 offen offset:0 sc1
    s_waitcnt vmcnt(13)
    v_mfma_f32_32x32x16_bf16 v[32:47], a[72:75], v[92:95], v[32:47]
    v_mfma_f32_32x32x16_bf16 v[48:63], a[76:79], v[88:91], v[48:63]
    buffer_load_dwordx4 v[84:87], v1, s[12:15], s85 offen offset:0 sc1
    v_mfma_f32_32x32x16_bf16 v[64:79], a[76:79], v[92:95], v[64:79]
    s_waitcnt vmcnt(13)
    v_mfma_f32_32x32x16_bf16 v[16:31], a[80:83], v[96:99], v[16:31]
    buffer_load_dwordx4 v[88:91], v1, s[12:15], s84 offen offset:1024 sc1
    s_waitcnt vmcnt(13)
    v_mfma_f32_32x32x16_bf16 v[32:47], a[80:83], v[100:103], v[32:47]
    v_mfma_f32_32x32x16_bf16 v[48:63], a[84:87], v[96:99], v[48:63]
    buffer_load_dwordx4 v[92:95], v1, s[12:15], s85 offen offset:1024 sc1
    v_mfma_f32_32x32x16_bf16 v[64:79], a[84:87], v[100:103], v[64:79]
    s_waitcnt vmcnt(13)
    v_mfma_f32_32x32x16_bf16 v[16:31], a[88:91], v[104:107], v[16:31]
    buffer_load_dwordx4 v[96:99], v1, s[12:15], s84 offen offset:2048 sc1
    s_waitcnt vmcnt(13)
    v_mfma_f32_32x32x16_bf16 v[32:47], a[88:91], v[108:111], v[32:47]
    v_mfma_f32_32x32x16_bf16 v[48:63], a[92:95], v[104:107], v[48:63]
    buffer_load_dwordx4 v[100:103], v1, s[12:15], s85 offen offset:2048 sc1
    v_mfma_f32_32x32x16_bf16 v[64:79], a[92:95], v[108:111], v[64:79]
    s_waitcnt vmcnt(13)
    v_mfma_f32_32x32x16_bf16 v[16:31], a[96:99], v[112:115], v[16:31]
    buffer_load_dwordx4 v[104:107], v1, s[12:15], s84 offen offset:3072 sc1
    s_waitcnt vmcnt(13)
    v_mfma_f32_32x32x16_bf16 v[32:47], a[96:99], v[116:119], v[32:47]
    s_add_u32 s84, s84, 4096
    v_mfma_f32_32x32x16_bf16 v[48:63], a[100:103], v[112:115], v[48:63]
    buffer_load_dwordx4 v[108:111], v1, s[12:15], s85 offen offset:3072 sc1
    v_mfma_f32_32x32x16_bf16 v[64:79], a[100:103], v[116:119], v[64:79]
    s_add_u32 s85, s85, 4096
    s_waitcnt vmcnt(13)
    v_mfma_f32_32x32x16_bf16 v[16:31], a[104:107], v[120:123], v[16:31]
    buffer_load_dwordx4 v[112:115], v1, s[12:15], s84 offen offset:0 sc1
    s_waitcnt vmcnt(13)
    v_mfma_f32_32x32x16_bf16 v[32:47], a[104:107], v[124:127], v[32:47]
    v_mfma_f32_32x32x16_bf16 v[48:63], a[108:111], v[120:123], v[48:63]
    buffer_load_dwordx4 v[116:119], v1, s[12:15], s85 offen offset:0 sc1
    v_mfma_f32_32x32x16_bf16 v[64:79], a[108:111], v[124:127], v[64:79]
    s_waitcnt vmcnt(13)
    v_mfma_f32_32x32x16_bf16 v[16:31], a[112:115], v[128:131], v[16:31]
    buffer_load_dwordx4 v[120:123], v1, s[12:15], s84 offen offset:1024 sc1
    s_waitcnt vmcnt(13)
    v_mfma_f32_32x32x16_bf16 v[32:47], a[112:115], v[132:135], v[32:47]
    v_mfma_f32_32x32x16_bf16 v[48:63], a[116:119], v[128:131], v[48:63]
    buffer_load_dwordx4 v[124:127], v1, s[12:15], s85 offen offset:1024 sc1
    v_mfma_f32_32x32x16_bf16 v[64:79], a[116:119], v[132:135], v[64:79]
    s_waitcnt vmcnt(13)
    v_mfma_f32_32x32x16_bf16 v[16:31], a[120:123], v[136:139], v[16:31]
    buffer_load_dwordx4 v[128:131], v1, s[12:15], s84 offen offset:2048 sc1
    s_waitcnt vmcnt(13)
    v_mfma_f32_32x32x16_bf16 v[32:47], a[120:123], v[140:143], v[32:47]
    v_mfma_f32_32x32x16_bf16 v[48:63], a[124:127], v[136:139], v[48:63]
    buffer_load_dwordx4 v[132:135], v1, s[12:15], s85 offen offset:2048 sc1
    v_mfma_f32_32x32x16_bf16 v[64:79], a[124:127], v[140:143], v[64:79]
    s_waitcnt vmcnt(13)
    v_mfma_f32_32x32x16_bf16 v[16:31], a[128:131], v[80:83], v[16:31]
    buffer_load_dwordx4 v[136:139], v1, s[12:15], s84 offen offset:3072 sc1
    s_waitcnt vmcnt(13)
    v_mfma_f32_32x32x16_bf16 v[32:47], a[128:131], v[84:87], v[32:47]
    s_add_u32 s84, s84, 4096
    v_mfma_f32_32x32x16_bf16 v[48:63], a[132:135], v[80:83], v[48:63]
    buffer_load_dwordx4 v[140:143], v1, s[12:15], s85 offen offset:3072 sc1
    v_mfma_f32_32x32x16_bf16 v[64:79], a[132:135], v[84:87], v[64:79]
    s_add_u32 s85, s85, 4096
    s_waitcnt vmcnt(13)
    v_mfma_f32_32x32x16_bf16 v[16:31], a[136:139], v[88:91], v[16:31]
    buffer_load_dwordx4 v[80:83], v1, s[12:15], s84 offen offset:0 sc1
    s_waitcnt vmcnt(13)
    v_mfma_f32_32x32x16_bf16 v[32:47], a[136:139], v[92:95], v[32:47]
    v_mfma_f32_32x32x16_bf16 v[48:63], a[140:143], v[88:91], v[48:63]
    buffer_load_dwordx4 v[84:87], v1, s[12:15], s85 offen offset:0 sc1
    v_mfma_f32_32x32x16_bf16 v[64:79], a[140:143], v[92:95], v[64:79]
    s_waitcnt vmcnt(13)
    v_mfma_f32_32x32x16_bf16 v[16:31], a[144:147], v[96:99], v[16:31]
    buffer_load_dwordx4 v[88:91], v1, s[12:15], s84 offen offset:1024 sc1
    s_waitcnt vmcnt(13)
    v_mfma_f32_32x32x16_bf16 v[32:47], a[144:147], v[100:103], v[32:47]
    v_mfma_f32_32x32x16_bf16 v[48:63], a[148:151], v[96:99], v[48:63]
    buffer_load_dwordx4 v[92:95], v1, s[12:15], s85 offen offset:1024 sc1
    v_mfma_f32_32x32x16_bf16 v[64:79], a[148:151], v[100:103], v[64:79]
    s_waitcnt vmcnt(13)
    v_mfma_f32_32x32x16_bf16 v[16:31], a[152:155], v[104:107], v[16:31]
    buffer_load_dwordx4 v[96:99], v1, s[12:15], s84 offen offset:2048 sc1
    s_waitcnt vmcnt(13)
    v_mfma_f32_32x32x16_bf16 v[32:47], a[152:155], v[108:111], v[32:47]
    v_mfma_f32_32x32x16_bf16 v[48:63], a[156:159], v[104:107], v[48:63]
    buffer_load_dwordx4 v[100:103], v1, s[12:15], s85 offen offset:2048 sc1
    v_mfma_f32_32x32x16_bf16 v[64:79], a[156:159], v[108:111], v[64:79]
    s_waitcnt vmcnt(13)
    v_mfma_f32_32x32x16_bf16 v[16:31], a[160:163], v[112:115], v[16:31]
    buffer_load_dwordx4 v[104:107], v1, s[12:15], s84 offen offset:3072 sc1
    s_waitcnt vmcnt(13)
    v_mfma_f32_32x32x16_bf16 v[32:47], a[160:163], v[116:119], v[32:47]
    s_add_u32 s84, s84, 4096
    v_mfma_f32_32x32x16_bf16 v[48:63], a[164:167], v[112:115], v[48:63]
    buffer_load_dwordx4 v[108:111], v1, s[12:15], s85 offen offset:3072 sc1
    v_mfma_f32_32x32x16_bf16 v[64:79], a[164:167], v[116:119], v[64:79]
    s_add_u32 s85, s85, 4096
    s_waitcnt vmcnt(13)
    v_mfma_f32_32x32x16_bf16 v[16:31], a[168:171], v[120:123], v[16:31]
    s_waitcnt vmcnt(12)
    v_mfma_f32_32x32x16_bf16 v[32:47], a[168:171], v[124:127], v[32:47]
    v_mfma_f32_32x32x16_bf16 v[48:63], a[172:175], v[120:123], v[48:63]
    v_mfma_f32_32x32x16_bf16 v[64:79], a[172:175], v[124:127], v[64:79]
    s_waitcnt vmcnt(11)
    v_mfma_f32_32x32x16_bf16 v[16:31], a[176:179], v[128:131], v[16:31]
    s_waitcnt vmcnt(10)
    v_mfma_f32_32x32x16_bf16 v[32:47], a[176:179], v[132:135], v[32:47]
    v_mfma_f32_32x32x16_bf16 v[48:63], a[180:183], v[128:131], v[48:63]
    v_mfma_f32_32x32x16_bf16 v[64:79], a[180:183], v[132:135], v[64:79]
    s_waitcnt vmcnt(9)
    v_mfma_f32_32x32x16_bf16 v[16:31], a[184:187], v[136:139], v[16:31]
    s_waitcnt vmcnt(8)
    v_mfma_f32_32x32x16_bf16 v[32:47], a[184:187], v[140:143], v[32:47]
    v_mfma_f32_32x32x16_bf16 v[48:63], a[188:191], v[136:139], v[48:63]
    v_mfma_f32_32x32x16_bf16 v[64:79], a[188:191], v[140:143], v[64:79]
    s_waitcnt vmcnt(7)
    v_mfma_f32_32x32x16_bf16 v[16:31], a[192:195], v[80:83], v[16:31]
    s_waitcnt vmcnt(6)
    v_mfma_f32_32x32x16_bf16 v[32:47], a[192:195], v[84:87], v[32:47]
    v_mfma_f32_32x32x16_bf16 v[48:63], a[196:199], v[80:83], v[48:63]
    v_mfma_f32_32x32x16_bf16 v[64:79], a[196:199], v[84:87], v[64:79]
    s_waitcnt vmcnt(5)
    v_mfma_f32_32x32x16_bf16 v[16:31], a[200:203], v[88:91], v[16:31]
    s_waitcnt vmcnt(4)
    v_mfma_f32_32x32x16_bf16 v[32:47], a[200:203], v[92:95], v[32:47]
    v_mfma_f32_32x32x16_bf16 v[48:63], a[204:207], v[88:91], v[48:63]
    v_mfma_f32_32x32x16_bf16 v[64:79], a[204:207], v[92:95], v[64:79]
    s_waitcnt vmcnt(3)
    v_mfma_f32_32x32x16_bf16 v[16:31], a[208:211], v[96:99], v[16:31]
    s_waitcnt vmcnt(2)
    v_mfma_f32_32x32x16_bf16 v[32:47], a[208:211], v[100:103], v[32:47]
    v_mfma_f32_32x32x16_bf16 v[48:63], a[212:215], v[96:99], v[48:63]
    v_mfma_f32_32x32x16_bf16 v[64:79], a[212:215], v[100:103], v[64:79]
    s_waitcnt vmcnt(0)
    v_mfma_f32_32x32x16_bf16 v[64:79], a[220:223], v[108:111], v[64:79]
    v_mfma_f32_32x32x16_bf16 v[48:63], a[220:223], v[104:107], v[48:63]
    v_mfma_f32_32x32x16_bf16 v[32:47], a[216:219], v[108:111], v[32:47]
    v_mfma_f32_32x32x16_bf16 v[16:31], a[216:219], v[104:107], v[16:31]
    s_nop 9
    ds_write_b128 v13, v[48:51] offset:0
    ds_write_b128 v13, v[52:55] offset:1024
    ds_write_b128 v13, v[56:59] offset:2048
    ds_write_b128 v13, v[60:63] offset:3072
    ds_write_b128 v14, v[32:35] offset:0
    ds_write_b128 v14, v[36:39] offset:1024
    ds_write_b128 v14, v[40:43] offset:2048
    ds_write_b128 v14, v[44:47] offset:3072
    ds_write_b128 v15, v[64:67] offset:0
    ds_write_b128 v15, v[68:71] offset:1024
    ds_write_b128 v15, v[72:75] offset:2048
    ds_write_b128 v15, v[76:79] offset:3072
    s_waitcnt lgkmcnt(0)
    s_barrier
    ds_read_b128 v[32:35], v12 offset:0
    ds_read_b128 v[36:39], v12 offset:1024
    ds_read_b128 v[40:43], v12 offset:2048
    ds_read_b128 v[44:47], v12 offset:3072
    ds_read_b128 v[48:51], v12 offset:4096
    ds_read_b128 v[52:55], v12 offset:5120
    ds_read_b128 v[56:59], v12 offset:6144
    ds_read_b128 v[60:63], v12 offset:7168
    ds_read_b128 v[64:67], v12 offset:8192
    ds_read_b128 v[68:71], v12 offset:9216
    ds_read_b128 v[72:75], v12 offset:10240
    ds_read_b128 v[76:79], v12 offset:11264
    s_waitcnt lgkmcnt(11)
    v_pk_add_f32 v[16:17], v[16:17], v[32:33]
    v_pk_add_f32 v[18:19], v[18:19], v[34:35]
    s_waitcnt lgkmcnt(10)
    v_pk_add_f32 v[20:21], v[20:21], v[36:37]
    v_pk_add_f32 v[22:23], v[22:23], v[38:39]
    s_waitcnt lgkmcnt(9)
    v_pk_add_f32 v[24:25], v[24:25], v[40:41]
    v_pk_add_f32 v[26:27], v[26:27], v[42:43]
    s_waitcnt lgkmcnt(8)
    v_pk_add_f32 v[28:29], v[28:29], v[44:45]
    v_pk_add_f32 v[30:31], v[30:31], v[46:47]
    s_waitcnt lgkmcnt(3)
    v_pk_add_f32 v[48:49], v[48:49], v[64:65]
    v_pk_add_f32 v[50:51], v[50:51], v[66:67]
    s_waitcnt lgkmcnt(2)
    v_pk_add_f32 v[52:53], v[52:53], v[68:69]
    v_pk_add_f32 v[54:55], v[54:55], v[70:71]
    s_waitcnt lgkmcnt(1)
    v_pk_add_f32 v[56:57], v[56:57], v[72:73]
    v_pk_add_f32 v[58:59], v[58:59], v[74:75]
    s_waitcnt lgkmcnt(0)
    v_pk_add_f32 v[60:61], v[60:61], v[76:77]
    v_pk_add_f32 v[62:63], v[62:63], v[78:79]
    v_pk_add_f32 v[16:17], v[16:17], v[48:49]
    v_pk_add_f32 v[18:19], v[18:19], v[50:51]
    v_pk_add_f32 v[20:21], v[20:21], v[52:53]
    v_pk_add_f32 v[22:23], v[22:23], v[54:55]
    v_pk_add_f32 v[24:25], v[24:25], v[56:57]
    v_pk_add_f32 v[26:27], v[26:27], v[58:59]
    v_pk_add_f32 v[28:29], v[28:29], v[60:61]
    v_pk_add_f32 v[30:31], v[30:31], v[62:63]
    v_pk_fma_f32 v[176:177], v[144:145], v[16:17], v[176:177]
    v_pk_fma_f32 v[178:179], v[146:147], v[18:19], v[178:179]
    v_pk_fma_f32 v[180:181], v[148:149], v[20:21], v[180:181]
    v_pk_fma_f32 v[182:183], v[150:151], v[22:23], v[182:183]
    v_pk_fma_f32 v[184:185], v[152:153], v[24:25], v[184:185]
    v_pk_fma_f32 v[186:187], v[154:155], v[26:27], v[186:187]
    v_pk_fma_f32 v[188:189], v[156:157], v[28:29], v[188:189]
    v_pk_fma_f32 v[190:191], v[158:159], v[30:31], v[190:191]
    v_cvt_pk_bf16_f32 v48, v176, v177
    v_cvt_pk_bf16_f32 v49, v178, v179
    v_cvt_pk_bf16_f32 v50, v180, v181
    v_cvt_pk_bf16_f32 v51, v182, v183
    v_cvt_pk_bf16_f32 v52, v184, v185
    v_cvt_pk_bf16_f32 v53, v186, v187
    v_cvt_pk_bf16_f32 v54, v188, v189
    v_cvt_pk_bf16_f32 v55, v190, v191
    v_permlane32_swap_b32 v48, v50
    v_permlane32_swap_b32 v49, v51
    v_permlane32_swap_b32 v52, v54
    v_permlane32_swap_b32 v53, v55
    buffer_store_dwordx4 v[48:51], v10, s[20:23], s86 offen offset:0
    buffer_store_dwordx4 v[52:55], v10, s[20:23], s86 offen offset:32
    s_cmp_eq_u32 s100, 1
    s_cbranch_scc1 L_noepoch_24
    v_bfe_u32 v12, v0, 3, 2
    v_lshlrev_b32 v12, 7, v12
    v_and_b32 v15, 7, v0
    v_lshl_add_u32 v12, v15, 2, v12
    v_lshrrev_b32 v13, 5, v0
    v_lshl_add_u32 v12, v13, 9, v12
    s_mov_b32 s26, 36864
    s_and_b32 s27, s96, 0x0fffffff
    s_mov_b32 s101, 0
L_spin_25:
    buffer_load_dword v16, v12, s[12:15], s26 offen offset:0 sc1
    buffer_load_dword v17, v12, s[12:15], s26 offen offset:1024 sc1
    buffer_load_dword v18, v12, s[12:15], s26 offen offset:2048 sc1
    buffer_load_dword v19, v12, s[12:15], s26 offen offset:3072 sc1
    s_waitcnt vmcnt(0)
    v_lshrrev_b32 v16, 4, v16
    v_lshrrev_b32 v17, 4, v17
    v_lshrrev_b32 v18, 4, v18
    v_lshrrev_b32 v19, 4, v19
    v_cmp_eq_u32 vcc, s27, v16
    v_cmp_eq_u32 s[28:29], s27, v17
    s_nop 0
    s_and_b64 vcc, vcc, s[28:29]
    v_cmp_eq_u32 s[28:29], s27, v18
    s_nop 0
    s_and_b64 vcc, vcc, s[28:29]
    v_cmp_eq_u32 s[28:29], s27, v19
    s_nop 0
    s_and_b64 vcc, vcc, s[28:29]
    s_cmp_eq_u64 vcc, exec
    s_cbranch_scc1 L_spun_26
    s_add_u32 s101, s101, 1
    s_cmp_lt_u32 s101, 1048576
    s_cbranch_scc1 L_spin_25
L_spun_26:
    v_mov_b32 v12, 0
    v_mov_b32 v13, s96
    s_mov_b32 s26, 32768
    buffer_store_dword v13, v12, s[12:15], s26 offen sc1
L_noepoch_24:
L_code_end:
L_end_adaLN_cond__sliding_local_dilated__glu_gated_glu__prompt_kernel:
    s_endpgm

.section .rodata,"a"
.p2align 6
.amdhsa_kernel adaLN_cond__sliding_local_dilated__glu_gated_glu__prompt_kernel
  .amdhsa_next_free_vgpr 512
  .amdhsa_next_free_sgpr 102
  .amdhsa_accum_offset 256
  .amdhsa_group_segment_fixed_size 0
  .amdhsa_kernarg_size 96
  .amdhsa_user_sgpr_count 2
  .amdhsa_user_sgpr_kernarg_segment_ptr 1
  .amdhsa_system_sgpr_workgroup_id_x 1
  .amdhsa_float_denorm_mode_32 3
.end_amdhsa_kernel
```
